```python
import torch

def _softmax(x, axis=-1):
    return torch.softmax(x, dim=axis)
def _gelu(x):
    return torch.nn.functional.gelu(x, approximate="tanh")
def _silu(x):
    return torch.nn.functional.silu(x)
def _sigmoid(x):
    return torch.sigmoid(x)
def _layernorm(x, axis=-1, eps=1e-5):
    m = x.mean(dim=axis, keepdim=True)
    v = x.var(dim=axis, keepdim=True, unbiased=False)
    return (x - m) / torch.sqrt(v + eps)
def _scatter_add(tgt, idx, src, axis=0):
    return tgt.clone().index_add_(axis, idx, src)
def _segment_sum(src, seg, n):
    out = torch.zeros((n,) + src.shape[1:], dtype=src.dtype)
    return out.index_add_(0, seg, src)
def _pad(x, pw):
    flat = tuple(v for pair in reversed(pw) for v in pair)
    return torch.nn.functional.pad(x, flat)

kernel_name = 'sequential_preLN__ssm_conv_h3__dense_activation_mish__prompt'

def setup_inputs():

    _w = (lambda a: (lambda t: t.to(torch.bfloat16) if t.is_floating_point() else t)(torch.as_tensor(a)))
    def _A_setup():
        B, S, D = 1, 2048, 448
        ks = 4
        return {
            "q": _w((lambda *s: torch.randn(*s, dtype=torch.bfloat16) * 0.05)(B, S, D)),
            "k": _w((lambda *s: torch.randn(*s, dtype=torch.bfloat16) * 0.2)(B, S, D)),
            "v": _w((lambda *s: torch.randn(*s, dtype=torch.bfloat16) * 0.2)(B, S, D)),
            "shift_k": _w((lambda *s: torch.randn(*s, dtype=torch.bfloat16) * 0.2)(D, ks) * 0.5),
            "ssm_k": _w((lambda *s: torch.randn(*s, dtype=torch.bfloat16) * 0.8)(D, S) * (1.0 / S ** 0.5)),
            "ssm_D": _w((lambda *s: torch.randn(*s, dtype=torch.bfloat16) * 0.2)(D)),
        }
    _A_in = _A_setup()

    def _B_setup():
        B, S, D, F = 1, 2048, 448, 1792
        return {
            "x": _w((lambda *s: torch.randn(*s, dtype=torch.bfloat16) * 0.05)(B, S, D)),
            "w1": _w((lambda *s: torch.randn(*s, dtype=torch.bfloat16) * 0.8)(D, F) * (D ** -0.5)),
            "b1": _w((lambda *s: torch.randn(*s, dtype=torch.bfloat16) * 0.2)(F)),
            "w2": _w((lambda *s: torch.randn(*s, dtype=torch.bfloat16) * 0.1)(F, D) * (F ** -0.5)),
        }
    _B_in = _B_setup()

    return {
        "A_q": _A_in["q"],
        "A_k": _A_in["k"],
        "A_v": _A_in["v"],
        "A_shift_k": _A_in["shift_k"],
        "A_ssm_k": _A_in["ssm_k"],
        "A_ssm_D": _A_in["ssm_D"],
        "B_x": _B_in["x"],
        "B_w1": _B_in["w1"],
        "B_b1": _B_in["b1"],
        "B_w2": _B_in["w2"],
    }

def reference(A_q, A_k, A_v, A_shift_k, A_ssm_k, A_ssm_D, B_x, B_w1, B_b1, B_w2):
    def _A_ref(q, k, v, shift_k, ssm_k, ssm_D):
        B, S, D = q.shape
        ks = shift_k.shape[-1]
        k_pad = _pad(k, ((0, 0), (ks - 1, 0), (0, 0)))
        k_shift = torch.zeros_like(k)
        for t in range(ks):
            k_shift = k_shift + k_pad[:, t:t + S, :] * shift_k[:, ks - 1 - t][None, None, :]
        kv = k_shift * v
        L = 2 * S
        kv_pad = _pad(kv, ((0, 0), (0, S), (0, 0)))
        kf_pad = _pad(ssm_k, ((0, 0), (0, S)))
        kv_f = (lambda x, axes=(-2,-1): torch.fft.rfft2(x.float(), dim=axes))(kv_pad[:, None, :, :], axes=(1, 2))
        kf_f = (lambda x, axes=(-2,-1): torch.fft.rfft2(x.float(), dim=axes))(kf_pad[:, None, :], axes=(1, 2))
        kf_f = (lambda x, *d: x.permute(*d))(kf_f, 1, 2, 0)
        y_f = kv_f * kf_f[None, :, :, :]
        y = (lambda x, s, axes=(-2,-1): torch.fft.irfft2(x, s=s, dim=axes).to(torch.bfloat16))(y_f, (1, L), axes=(1, 2))[:, 0, :S, :]
        y = y + kv * ssm_D[None, None, :]
        return q * y

    def _B_ref(x, w1, b1, w2):
        h = torch.einsum("bsd,df->bsf", x, w1) + b1
        sp = torch.log1p(torch.exp(-torch.abs(h))) + torch.where(h > 0, h, torch.zeros_like(h))
        act = h * torch.tanh(sp)
        return torch.einsum("bsf,fd->bsd", act, w2)

    x = A_q
    h = x + _A_ref(_layernorm(x, axis=-1), A_k, A_v, A_shift_k, A_ssm_k, A_ssm_D)
    h2 = h + _B_ref(_layernorm(h, axis=-1), B_w1, B_b1, B_w2)
    return h2
```

```asm
; @launch grid=(256,1,1) block=(256,1,1) lds=163840
.amdgcn_target "amdgcn-amd-amdhsa--gfx950"
.text
.globl sequential_preLN__ssm_conv_h3__dense_activation_mish__prompt_kernel
.p2align 12
.p2align 8
.type sequential_preLN__ssm_conv_h3__dense_activation_mish__prompt_kernel,@function
sequential_preLN__ssm_conv_h3__dense_activation_mish__prompt_kernel:
    s_cmpk_ge_u32 s2, 0x100
    s_cbranch_scc1 END
    s_load_dwordx2 s[8:9], s[0:1], 8
    s_load_dwordx2 s[12:13], s[0:1], 16
    s_load_dwordx2 s[4:5], s[0:1], 0
    s_load_dwordx2 s[16:17], s[0:1], 24
    s_load_dwordx2 s[20:21], s[0:1], 32
    s_load_dwordx2 s[24:25], s[0:1], 40
    s_load_dwordx2 s[28:29], s[0:1], 56
    s_load_dwordx2 s[32:33], s[0:1], 64
    s_load_dwordx2 s[36:37], s[0:1], 72
    s_load_dwordx2 s[40:41], s[0:1], 80
    s_load_dwordx2 s[44:45], s[0:1], 88
    s_load_dwordx2 s[48:49], s[0:1], 96
    s_getpc_b64 s[58:59]
PCREF:
    v_and_b32 v1, 63, v0
    v_lshrrev_b32 v4, 6, v0
    s_lshr_b32 s53, s2, 3
    v_lshl_add_u32 v2, s53, 2, v4
    v_readfirstlane_b32 s54, v4
    v_mul_u32_u24 v2, 3, v2
    v_min_u32_e64 v3, 2, v1
    v_add_lshl_u32 v2, v2, v3, 7
    v_min_u32 v2, CODE_END-PCREF-4, v2
    v_mov_b32 v3, s59
    v_add_co_u32 v2, vcc, s58, v2
    s_and_b32 s52, s2, 7
    s_xor_b32 s52, s52, 6
    v_lshrrev_b32 v255, 3, v1
    v_addc_co_u32 v3, vcc, 0, v3, vcc
    v_and_b32_e64 v6, 7, v1
    global_load_dword v247, v[2:3], off
    s_mov_b32 s6, 1835008
    s_mov_b32 s7, 0x20000
    s_mov_b32 s10, 1835008
    s_mov_b32 s11, 0x20000
    s_mov_b32 s14, 1835008
    s_mov_b32 s15, 0x20000
    s_mov_b32 s18, 3584
    s_mov_b32 s19, 0x20000
    s_mov_b32 s22, 1835008
    s_mov_b32 s23, 0x20000
    s_mov_b32 s26, 896
    s_mov_b32 s27, 0x20000
    s_mov_b32 s30, 1605632
    s_mov_b32 s31, 0x20000
    s_mov_b32 s34, 3584
    s_mov_b32 s35, 0x20000
    s_mov_b32 s38, 1605632
    s_mov_b32 s39, 0x20000
    s_mov_b32 s42, 1835008
    s_mov_b32 s43, 0x20000
    s_mov_b32 s46, 256
    s_mov_b32 s47, 0x20000
    s_mov_b32 s50, 268435456
    s_mov_b32 s51, 0x20000
    s_mul_i32 s60, s53, 37
    s_lshr_b32 s60, s60, 8
    s_mul_i32 s61, s60, 7
    s_sub_u32 s56, s53, s61
    s_lshl_b32 s55, s52, 2
    s_add_u32 s55, s55, s60
    s_cmp_ge_u32 s53, 28
    s_cselect_b32 s30, 0, s30
    s_cselect_b32 s38, 0, s38
    v_lshlrev_b32_e64 v251, 4, v1
    s_getreg_b32 s58, hwreg(HW_REG_XCC_ID, 0, 4)
    s_lshl_b32 s59, s52, 5
    s_or_b32 s58, s58, 0x80
    s_add_u32 s60, s59, s53
    s_mul_i32 s26, s58, 0x01010101
    s_cmp_ge_u32 s60, 252
    s_cselect_b32 s60, 0x1000, s60
    v_mov_b32 v236, s58
    v_cmp_eq_u32 vcc, 0, v0
    v_bfrev_b32 v237, 1
    v_mov_b32 v239, s60
    v_cndmask_b32_e64 v237, v237, v239, vcc
    v_lshl_add_u32 v239, v6, 2, s59
    v_min_u32 v239, 248, v239
    s_cmp_eq_u32 s52, 7
    s_cbranch_scc1 STATS
    s_lshl_b32 s58, s53, 6
    s_lshl_b32 s59, s54, 4
    s_add_u32 s58, s58, s59
    s_mul_i32 s58, s58, 896
    s_lshl_b32 s59, s52, 7
    s_add_u32 s58, s58, s59
    v_and_b32 v7, 2, v255
    v_xor_b32 v7, v7, v6
    v_lshlrev_b32 v7, 4, v7
    v_mul_u32_u24 v8, 896, v255
    v_add3_u32 v7, v7, v8, s58
    v_xor_b32_e64 v9, 64, v7
    v_add_u32 v8, 6144, v9
    v_subrev_u32 v9, 7168, v9
    s_lshl_b32 s67, s54, 11
    v_and_b32 v10, 15, v1
    s_lshl_b32 s60, s52, 6
    s_lshl_b32 s59, s54, 4
    s_add_u32 s58, s60, s59
    v_add_u32 v18, s58, v10
    v_lshlrev_b32 v13, 3, v18
    s_lshl_b32 s59, s53, 1
    s_add_u32 s58, s60, s59
    s_lshl_b32 s63, s58, 1
    s_lshr_b32 s59, s54, 1
    s_add_u32 s66, s58, s59
    s_and_b32 s65, s54, 1
    s_lshl_b32 s58, s66, 12
    s_lshl_b32 s59, s65, 11
    s_add_u32 s58, s58, s59
    v_add_u32 v11, s58, v251
    v_add_u32 v10, -16, v11
    v_or_b32 v12, s65, v1
    v_cmp_eq_u32 vcc, 0, v12
    v_bfrev_b32 v12, 1
    s_nop 0
    v_cndmask_b32 v10, v10, v12, vcc
    s_waitcnt lgkmcnt(0)
    buffer_store_byte v236, v237, s[44:47], 0 offen
    s_or_b32 s58, s2, s54
    s_cmp_lg_u32 s58, 0
    s_cbranch_scc1 nononce_1
    s_memrealtime s[58:59]
    v_mov_b32 v3, 0
    s_waitcnt lgkmcnt(0)
    s_or_b32 s58, s58, 1
    v_mov_b32_e64 v2, s58
    s_mov_b64 exec, 1
    buffer_store_dword v2, v3, s[44:47], 0 offen offset:252 sc1
    s_mov_b64 exec, -1
nononce_1:
    s_cmp_lg_u32 s54, 0
    s_cbranch_scc1 nohalo_2
    s_mov_b32 m0, 0
    s_nop 0
    buffer_load_dwordx4 v9, s[8:11], 0 offen lds
nohalo_2:
    s_add_u32 m0, s67, 1024
    s_nop 0
    buffer_load_dwordx4 v7, s[8:11], 0 offen lds
    buffer_load_dwordx4 v8, s[8:11], 0 offen offset:1024 lds
    s_add_u32 m0, s67, 9216
    s_nop 0
    buffer_load_dwordx4 v7, s[12:15], 0 offen lds
    buffer_load_dwordx4 v8, s[12:15], 0 offen offset:1024 lds
    buffer_load_dwordx2 v[16:17], v13, s[16:19], 0 offen
    s_add_u32 m0, s67, 17408
    s_load_dword s3, s[24:25], s63
    v_mov_b32 v159, v10
    v_mov_b32 v9, v11
    s_mul_i32 s58, s52, 28
    s_add_u32 s58, s58, s53
    s_lshl_b32 s58, s58, 2
    s_add_u32 s58, s58, s54
    s_mul_i32 s58, s58, 1792
    v_min_u32_e64 v246, 13, v1
    v_lshl_add_u32 v246, v246, 7, s58
    v_bfe_u32 v10, v255, 1, 1
    v_lshlrev_b32 v10, 2, v10
    v_xor_b32 v10, v10, v6
    v_lshlrev_b32 v254, 4, v10
    s_lshl_b32 s58, s56, 9
    s_lshl_b32 s59, s54, 7
    s_add_u32 s58, s58, s59
    v_mul_u32_u24 v11, 3584, v255
    v_add3_u32 v252, v254, v11, s58
    v_add_u32 v253, 27648, v252
    v_and_b32 v10, 31, v1
    v_lshlrev_b32 v10, 1, v10
    v_add_u32 v205, s58, v10
    s_lshl_b32 s69, s55, 3
    s_lshr_b32 s69, 3839418852, s69
    s_lshr_b32 s70, s69, 0
    s_add_u32 s70, s70, s54
    s_and_b32 s70, s70, 3
    s_mul_i32 s70, s70, 401408
    s_lshr_b32 s71, s69, 2
    s_add_u32 s71, s71, s54
    s_and_b32 s71, s71, 3
    s_mul_i32 s71, s71, 401408
    s_lshr_b32 s72, s69, 4
    s_add_u32 s72, s72, s54
    s_and_b32 s72, s72, 3
    s_mul_i32 s72, s72, 401408
    s_lshr_b32 s73, s69, 6
    s_add_u32 s73, s73, s54
    s_and_b32 s73, s73, 3
    s_mul_i32 s73, s73, 401408
    v_bfe_u32 v10, v1, 2, 2
    v_lshrrev_b32_e64 v11, 5, v1
    v_lshl_add_u32 v11, v11, 2, v10
    v_lshlrev_b32_e64 v250, 7, v11
    v_bfe_u32 v11, v1, 4, 1
    v_lshl_or_b32 v250, v11, 5, v250
    v_and_b32_e64 v11, 3, v1
    v_lshl_or_b32 v250, v11, 3, v250
    v_bfe_u32 v11, v1, 3, 1
    v_lshl_or_b32 v250, v11, 6, v250
    v_bfe_u32 v10, v1, 2, 1
    v_bfe_u32 v11, v1, 4, 1
    v_mov_b32 v12, 0x3f803f80
    v_cmp_eq_u32 vcc, v10, v11
    s_nop 1
    v_cndmask_b32 v200, 0, v12, vcc
    v_cndmask_b32 v201, 0, v12, vcc
    v_cndmask_b32_e64 v202, 0, v12, vcc
    v_cndmask_b32 v203, 0, v12, vcc
    s_lshr_b32 s59, s54, 1
    s_mul_i32 s64, s59, 33280
    s_add_u32 s64, s64, 34816
    s_mul_i32 s58, s59, 4608
    s_add_u32 s58, s58, 25600
    s_lshl_b32 s60, s66, 12
    v_and_b32 v160, 15, v1
    v_lshrrev_b32 v161, 4, v1
    v_and_b32 v162, 7, v1
    v_mul_u32_u24 v162, 4160, v162
    v_bfe_u32 v163, v1, 3, 1
    v_add_u32_e64 v163, v163, v161
    v_lshl_add_u32 v162, v163, 4, v162
    s_lshl_b32 s63, s65, 8
    s_add_u32 s59, s63, s64
    v_add_u32 v168, s59, v162
    v_lshlrev_b32 v162, 5, v160
    v_lshlrev_b32_e64 v163, 4, v161
    v_sub_u32 v169, v162, v163
    s_sub_u32 s59, s58, s63
    s_add_u32 s59, s59, 336
    v_add_u32 v169, s59, v169
    s_lshl_b32 s63, s65, 9
    v_lshl_add_u32 v164, v161, 3, v162
    s_add_u32 s61, s60, s63
    s_sub_u32 s62, s60, s63
    s_add_u32 s62, s62, 2560
    s_add_u32 s59, s61, 2097152
    v_add_u32_e64 v170, s59, v164
    s_add_u32 s59, s62, 2097152
    v_add_u32_e64 v171, s59, v164
    v_lshlrev_b32 v164, 1, v164
    s_lshl_b32 s59, s65, 10
    s_add_u32 s63, s59, 4194304
    v_add_u32_e64 v172, s63, v164
    s_sub_u32 s59, 4199424, s59
    v_add_u32 v173, s59, v164
    v_lshrrev_b32 v164, 1, v161
    v_lshl_add_u32 v164, v164, 9, v162
    v_lshrrev_b32 v164, 1, v164
    v_and_b32 v165, 1, v161
    v_lshl_add_u32 v164, v165, 10, v164
    s_add_u32 s59, s61, 5242880
    v_add_u32_e64 v175, s59, v164
    s_add_u32 s59, s62, 5242880
    v_add_u32 v176, s59, v164
    s_lshr_b32 s59, s60, 5
    s_and_b32 s59, s59, 384
    v_xor_b32_e64 v175, s59, v175
    v_xor_b32 v176, s59, v176
    s_lshl_b32 s59, s54, 12
    s_add_u32 s59, s59, 40960
    v_add_u32 v174, s59, v251
    v_and_b32 v160, 31, v1
    v_lshlrev_b32_e64 v160, 3, v160
    s_lshr_b32 s59, s53, 3
    s_lshl_b32 s60, s52, 2
    s_add_u32 s59, s59, s60
    s_lshl_b32 s59, s59, 8
    s_add_u32 s59, s59, 16777216
    v_add_u32_e64 v177, s59, v160
    v_add_u32 v161, 131072, v177
    v_add_u32 v162, 16784384, v160
    v_cmp_gt_u32_e64 vcc, 32, v1
    s_add_u32 s59, s60, s54
    s_lshl_b32 s59, s59, 5
    s_add_u32 s59, s59, s53
    s_lshl_b32 s59, s59, 3
    s_add_u32 s76, s59, 16777216
    v_cndmask_b32 v178, v162, v161, vcc
    s_lshl_b32 s59, s52, 5
    s_add_u32 s59, s59, s53
    s_lshl_b32 s59, s59, 5
    s_add_u32 s77, s59, 17039360
    s_mul_i32 s74, s54, 14336
    s_add_u32 s74, s74, 101376
    s_mul_i32 s75, s54, 6144
    v_add_u32 v248, s74, v250
    v_xor_b32 v249, 64, v248
    v_add_u32 v179, s75, v250
    v_xor_b32 v180, 64, v179
    v_lshrrev_b32_e64 v10, 4, v1
    v_bfe_u32 v11, v1, 2, 2
    v_lshl_add_u32 v12, v10, 3, v11
    v_lshlrev_b32 v12, 7, v12
    v_and_b32 v13, 3, v1
    v_lshlrev_b32 v13, 3, v13
    s_lshl_b32 s58, s54, 5
    v_or_b32 v13, s58, v13
    v_and_b32 v11, 2, v11
    v_lshlrev_b32 v11, 4, v11
    v_xor_b32 v13, v13, v11
    v_and_b32 v11, 1, v10
    v_lshlrev_b32 v11, 6, v11
    v_xor_b32 v13, v13, v11
    v_add_u32 v12, v12, v13
    v_xor_b32 v13, 64, v12
    s_lshl_b32 s58, s53, 7
    v_lshlrev_b32_e64 v14, 12, v18
    v_lshl_add_u32 v14, v10, 4, v14
    v_add_u32_e64 v14, s58, v14
    s_mov_b32 s68, 2097152
    s_mov_b32 s69, 131072
    buffer_load_dword v232, v177, s[48:51], 0 offen
    buffer_load_dword v230, v14, s[48:51], 0 offen
    buffer_load_dword v233, v177, s[48:51], s69 offen
    s_cmp_eq_u32 s54, 0
    s_cbranch_scc1 PAD1
    s_cmp_eq_u32 s54, 1
    s_cbranch_scc1 PAD2
    s_cmp_eq_u32 s54, 2
    s_cbranch_scc1 PAD3
    s_branch PAD4
HOPBACK:
    s_waitcnt lgkmcnt(0)
    s_lshr_b32 s59, s54, 1
    s_lshl_b32 s59, s59, 4
    s_lshr_b32 s3, s3, s59
    s_lshl_b32 s3, s3, 16
    s_cmp_eq_u32 s65, 0
    s_cselect_b32 s3, s3, 0
    s_lshl_b32 s59, s65, 11
    s_add_u32 s59, s59, s64
    s_add_u32 s59, s59, 16
    v_add_u32 v15, s59, v251
    v_mov_b32 v154, 0
    v_mov_b32 v155, 0
    v_mov_b32 v156, 0
    v_mov_b32 v157, 0
    v_min_u32_e64 v11, 7, v1
    v_mul_u32_u24 v11, 4160, v11
    v_add_u32 v11, s64, v11
    ds_write_b128 v11, v[154:157]
    s_lshr_b32 s58, s54, 1
    s_mul_i32 s58, s58, 4608
    s_add_u32 s58, s58, 25600
    v_and_b32 v11, 0x1f0, v251
    v_add_u32_e64 v11, s58, v11
    ds_write_b128 v11, v[154:157]
    v_cmp_eq_u32 vcc, 0, v1
    v_bfrev_b32 v158, 1
    s_nop 0
    v_cndmask_b32 v158, v158, 0, vcc
    s_lshl_b32 s61, s65, 11
    s_lshl_b32 s62, s66, 12
    s_add_u32 s62, s62, s61
    s_add_u32 s61, s61, s58
    s_add_u32 s61, s61, 512
    s_mov_b32 s63, 2097152
    s_mov_b32 s59, 0
    s_waitcnt vmcnt(3)
    buffer_load_dword v238, v239, s[44:47], 0 offen sc1
    buffer_load_dword v19, off, s[44:47], 0 offset:252 sc1
    buffer_load_dwordx4 v7, s[4:7], 0 offen lds
    buffer_load_dwordx4 v8, s[4:7], 0 offen offset:1024 lds
    buffer_load_dwordx4 v[20:23], v159, s[20:23], 0 offen
    buffer_load_dwordx4 v[24:27], v9, s[20:23], 0 offen
    buffer_load_dwordx4 v[28:31], v9, s[20:23], 0 offen offset:1008
    buffer_load_dwordx4 v[32:35], v9, s[20:23], 0 offen offset:1024
    buffer_load_dword v244, v246, s[28:31], 0 offen
    s_barrier
    ds_read_b64_tr_b16 v[40:41], v13 offset:512
    ds_read_b64_tr_b16 v[42:43], v12 offset:1024
    ds_read_b64_tr_b16 v[44:45], v12 offset:1536
    ds_read_b64_tr_b16 v[52:53], v12 offset:9216
    ds_read_b64_tr_b16 v[54:55], v12 offset:9728
    ds_read_b64_tr_b16 v[46:47], v13 offset:4608
    ds_read_b64_tr_b16 v[48:49], v12 offset:5120
    ds_read_b64_tr_b16 v[50:51], v12 offset:5632
    ds_read_b64_tr_b16 v[56:57], v12 offset:13312
    ds_read_b64_tr_b16 v[58:59], v12 offset:13824
    v_alignbit_b32 v92, v16, v16, 16
    v_alignbit_b32 v93, v17, v17, 16
    v_and_b32 v94, 0xffff, v16
    v_mov_b32 v10, 0xffff
    v_bfi_b32 v95, v10, v17, v16
    v_and_b32 v96, 0xffff0000, v17
    s_waitcnt lgkmcnt(8)
    v_dot2_f32_bf16 v69, v42, v92, 0
    v_dot2_f32_bf16 v68, v42, v94, 0
    v_dot2_f32_bf16 v71, v43, v92, 0
    v_dot2_f32_bf16 v70, v43, v94, 0
    s_waitcnt lgkmcnt(7)
    v_dot2_f32_bf16 v73, v44, v92, 0
    v_dot2_f32_bf16 v72, v44, v94, 0
    v_dot2_f32_bf16 v75, v45, v92, 0
    v_dot2_f32_bf16 v74, v45, v94, 0
    v_dot2_f32_bf16 v69, v41, v93, v69
    v_dot2_f32_bf16 v68, v41, v95, v68
    v_dot2_f32_bf16 v71, v42, v93, v71
    v_dot2_f32_bf16 v70, v42, v95, v70
    v_dot2_f32_bf16 v73, v43, v93, v73
    v_dot2_f32_bf16 v72, v43, v95, v72
    v_dot2_f32_bf16 v75, v44, v93, v75
    v_dot2_f32_bf16 v74, v44, v95, v74
    v_dot2_f32_bf16 v68, v40, v96, v68
    v_dot2_f32_bf16 v70, v41, v96, v70
    v_dot2_f32_bf16 v72, v42, v96, v72
    v_dot2_f32_bf16 v74, v43, v96, v74
    s_waitcnt lgkmcnt(6)
    v_lshlrev_b32 v98, 16, v52
    v_and_b32 v99, 0xffff0000, v52
    v_lshlrev_b32_e64 v100, 16, v53
    v_and_b32 v101, 0xffff0000, v53
    s_waitcnt lgkmcnt(5)
    v_lshlrev_b32 v102, 16, v54
    v_and_b32 v103, 0xffff0000, v54
    v_lshlrev_b32_e64 v104, 16, v55
    v_and_b32 v105, 0xffff0000, v55
    v_pk_mul_f32 v[68:69], v[68:69], v[98:99]
    v_pk_mul_f32 v[70:71], v[70:71], v[100:101]
    v_pk_mul_f32 v[72:73], v[72:73], v[102:103]
    v_pk_mul_f32 v[74:75], v[74:75], v[104:105]
    v_cvt_pk_bf16_f32 v84, v75, v74
    v_cvt_pk_bf16_f32 v85, v73, v72
    v_cvt_pk_bf16_f32 v86, v71, v70
    v_cvt_pk_bf16_f32 v87, v69, v68
    buffer_store_dwordx4 v[84:87], v14, s[48:51], 0 offen offset:0
    s_waitcnt lgkmcnt(3)
    v_dot2_f32_bf16 v77, v48, v92, 0
    v_dot2_f32_bf16 v76, v48, v94, 0
    v_dot2_f32_bf16 v79, v49, v92, 0
    v_dot2_f32_bf16 v78, v49, v94, 0
    s_waitcnt lgkmcnt(2)
    v_dot2_f32_bf16 v81, v50, v92, 0
    v_dot2_f32_bf16 v80, v50, v94, 0
    v_dot2_f32_bf16 v83, v51, v92, 0
    v_dot2_f32_bf16 v82, v51, v94, 0
    v_dot2_f32_bf16 v77, v47, v93, v77
    v_dot2_f32_bf16 v76, v47, v95, v76
    v_dot2_f32_bf16 v79, v48, v93, v79
    v_dot2_f32_bf16 v78, v48, v95, v78
    v_dot2_f32_bf16 v81, v49, v93, v81
    v_dot2_f32_bf16 v80, v49, v95, v80
    v_dot2_f32_bf16 v83, v50, v93, v83
    v_dot2_f32_bf16 v82, v50, v95, v82
    v_dot2_f32_bf16 v76, v46, v96, v76
    v_dot2_f32_bf16 v78, v47, v96, v78
    v_dot2_f32_bf16 v80, v48, v96, v80
    v_dot2_f32_bf16 v82, v49, v96, v82
    s_waitcnt lgkmcnt(1)
    v_lshlrev_b32 v98, 16, v56
    v_and_b32 v99, 0xffff0000, v56
    v_lshlrev_b32_e64 v100, 16, v57
    v_and_b32 v101, 0xffff0000, v57
    s_waitcnt lgkmcnt(0)
    v_lshlrev_b32 v102, 16, v58
    v_and_b32 v103, 0xffff0000, v58
    v_lshlrev_b32_e64 v104, 16, v59
    v_and_b32 v105, 0xffff0000, v59
    v_pk_mul_f32 v[76:77], v[76:77], v[98:99]
    v_pk_mul_f32 v[78:79], v[78:79], v[100:101]
    v_pk_mul_f32 v[80:81], v[80:81], v[102:103]
    v_pk_mul_f32 v[82:83], v[82:83], v[104:105]
    v_cvt_pk_bf16_f32 v88, v83, v82
    v_cvt_pk_bf16_f32 v89, v81, v80
    v_cvt_pk_bf16_f32 v90, v79, v78
    v_cvt_pk_bf16_f32 v91, v77, v76
    buffer_store_dwordx4 v[88:91], v14, s[48:51], 0 offen offset:64
    s_waitcnt vmcnt(5)
    v_lshlrev_b32 v36, 16, v24
    v_and_b32 v37, 0xffff0000, v24
    v_add_f32 v36, s3, v36
    v_cmp_eq_u32 vcc, 0, v1
    v_cvt_pk_bf16_f32 v36, v36, v37
    v_lshlrev_b32 v38, 16, v20
    v_cndmask_b32 v24, v24, v36, vcc
    v_and_b32 v37, 0xffff0000, v20
    v_add_f32 v38, s3, v38
    v_cmp_eq_u32 vcc, 1, v1
    v_cvt_pk_bf16_f32 v38, v38, v37
    s_nop 0
    v_cndmask_b32 v20, v20, v38, vcc
    ds_write_b128 v15, v[22:25] offset:12480
    v_mov_b32 v106, v21
    v_mov_b32 v107, v22
    v_mov_b32 v108, v23
    v_mov_b32 v109, v24
    ds_write_b128 v15, v[24:27] offset:29120
    v_mov_b32 v110, v25
    v_mov_b32 v111, v26
    v_alignbit_b32 v114, v21, v20, 16
    v_alignbit_b32 v115, v22, v21, 16
    ds_write_b128 v15, v[106:109] offset:4160
    v_alignbit_b32 v116, v23, v22, 16
    v_readfirstlane_b32 s57, v19
    s_cmp_lg_u32 s57, 0
    s_cbranch_scc1 npolld_4
    s_mov_b32 s69, 1000000
npoll_3:
    buffer_load_dword v19, off, s[44:47], 0 offset:252 sc1
    s_waitcnt vmcnt(0)
    v_readfirstlane_b32 s57, v19
    s_cmp_lg_u32 s57, 0
    s_cbranch_scc1 npolld_4
    s_sub_u32 s69, s69, 1
    s_cbranch_scc0 npoll_3
npolld_4:
    v_mov_b32 v39, s57
    v_cmp_ne_u32 vcc, s26, v238
    s_cmp_eq_u64 vcc, 0
    s_cselect_b32 s27, 1, 0
    s_waitcnt vmcnt(0)
    s_cbranch_scc0 rem_5
    buffer_store_dword v39, v158, s[48:51], s76 offen
back_6:
    s_barrier
    ds_read_b64_tr_b16 v[60:61], v12 offset:17408
    ds_read_b64_tr_b16 v[62:63], v12 offset:17920
    ds_read_b64_tr_b16 v[64:65], v12 offset:21504
    ds_read_b64_tr_b16 v[66:67], v12 offset:22016
    s_add_u32 s76, s76, 131072
    s_waitcnt lgkmcnt(2)
    s_waitcnt lgkmcnt(0)
    s_cmp_lg_u32 s27, 0
    s_cbranch_scc0 rem_7
    buffer_store_dwordx4 v[60:63], v14, s[48:51], s63 offen offset:0
    buffer_store_dwordx4 v[64:67], v14, s[48:51], s63 offen offset:64
back_8:
    v_alignbit_b32 v117, v24, v23, 16
    v_alignbit_b32 v118, v25, v24, 16
    v_alignbit_b32 v119, v26, v25, 16
    ds_write_b128 v15, v[108:111] offset:20800
    v_alignbit_b32 v122, v22, v21, 16
    v_alignbit_b32 v123, v23, v22, 16
    v_alignbit_b32 v124, v24, v23, 16
    v_alignbit_b32 v125, v25, v24, 16
    buffer_load_dword v19, v177, s[48:51], 0 offen sc1
    ds_write_b128 v15, v[114:117] offset:0
    v_alignbit_b32 v126, v26, v25, 16
    v_alignbit_b32 v127, v27, v26, 16
    ds_write_b128 v15, v[116:119] offset:16640
    ds_write_b128 v15, v[122:125] offset:8320
    ds_write_b128 v15, v[124:127] offset:24960
    ds_write_b128 v15, v[30:33] offset:13504
    v_mov_b32 v130, v29
    v_mov_b32 v131, v30
    v_mov_b32 v132, v31
    v_mov_b32 v133, v32
    ds_write_b128 v15, v[32:35] offset:30144
    v_mov_b32 v134, v33
    v_mov_b32 v135, v34
    v_alignbit_b32 v138, v29, v28, 16
    v_alignbit_b32 v139, v30, v29, 16
    s_add_u32 m0, s74, 0
    s_add_u32 s68, s70, 0
    buffer_load_dwordx4 v252, s[28:31], s68 offen lds
    ds_write_b128 v15, v[130:133] offset:5184
    s_branch SKIP1
PAD1:
    s_branch PAD5
SKIP1:
    v_alignbit_b32 v140, v31, v30, 16
    v_alignbit_b32 v141, v32, v31, 16
    v_alignbit_b32 v142, v33, v32, 16
    buffer_load_dwordx4 v253, s[28:31], s68 offen offset:1024 lds
    s_mov_b32 m0, s61
    s_waitcnt vmcnt(2)
    v_cmp_ne_u32 vcc, s57, v19
    s_cbranch_vccz polld_10
    s_mov_b32 s69, 1000000
poll_9:
    buffer_load_dword v19, v177, s[48:51], s59 offen sc1
    s_waitcnt vmcnt(0)
    v_cmp_ne_u32_e64 vcc, s57, v19
    s_cbranch_vccz polld_10
    s_sub_u32 s69, s69, 1
    s_cbranch_scc0 poll_9
polld_10:
    buffer_load_dwordx4 v251, s[48:51], s62 offen sc1 lds
    buffer_load_dwordx4 v251, s[48:51], s62 offen offset:1024 sc1 lds
    s_cmp_lg_u32 s27, 0
    s_cbranch_scc0 rem_11
    buffer_store_dword v39, v158, s[48:51], s76 offen
back_12:
    v_alignbit_b32 v143, v34, v33, 16
    ds_write_b128 v15, v[132:135] offset:21824
    v_alignbit_b32 v146, v30, v29, 16
    v_alignbit_b32 v147, v31, v30, 16
    v_alignbit_b32 v148, v32, v31, 16
    v_alignbit_b32 v149, v33, v32, 16
    ds_write_b128 v15, v[138:141] offset:1024
    v_alignbit_b32 v150, v34, v33, 16
    v_alignbit_b32 v151, v35, v34, 16
    ds_write_b128 v15, v[140:143] offset:17664
    ds_write_b128 v15, v[146:149] offset:9344
    ds_write_b128 v15, v[148:151] offset:25984
    s_add_u32 m0, s74, 2048
    s_add_u32 s68, s70, 57344
    buffer_load_dwordx4 v252, s[28:31], s68 offen lds
    buffer_load_dwordx4 v253, s[28:31], s68 offen offset:1024 lds
    s_add_u32 m0, s74, 4096
    s_add_u32 s68, s70, 114688
    buffer_load_dwordx4 v252, s[28:31], s68 offen lds
    buffer_load_dwordx4 v253, s[28:31], s68 offen offset:1024 lds
    s_waitcnt vmcnt(7)
    ds_read_b64_tr_b16 a[0:1], v248 offset:0
    ds_read_b64_tr_b16 a[2:3], v248 offset:1024
    ds_read_b64_tr_b16 a[4:5], v249 offset:0
    ds_read_b64_tr_b16 a[6:7], v249 offset:1024
    s_waitcnt lgkmcnt(0)
    s_waitcnt vmcnt(5)
    s_barrier
    buffer_load_dword v242, v246, s[36:39], 0 offen
    ds_read_b128 v[48:51], v168 offset:0
    ds_read_b128 v[108:111], v169 offset:3776
    ds_read_b128 v[104:107], v169 offset:3264
    ds_read_b128 v[100:103], v169 offset:2752
    ds_read_b128 v[96:99], v169 offset:2240
    ds_read_b128 v[92:95], v169 offset:1728
    ds_read_b128 v[88:91], v169 offset:1216
    ds_read_b128 v[84:87], v169 offset:704
    ds_read_b128 v[80:83], v169 offset:192
    ds_read_b128 v[52:55], v168 offset:512
    ds_read_b128 v[56:59], v168 offset:1024
    ds_read_b128 v[60:63], v168 offset:1536
    ds_read_b128 v[64:67], v168 offset:2048
    ds_read_b128 v[68:71], v168 offset:2560
    ds_read_b128 v[72:75], v168 offset:3072
    ds_read_b128 v[76:79], v168 offset:3584
    s_mov_b32 s59, 0
    s_mov_b32 s61, 8192
    s_waitcnt lgkmcnt(14)
    v_mfma_f32_16x16x32_bf16 v[44:47], v[48:51], v[108:111], 0
    ds_read_b128 v[108:111], v169 offset:3712
    s_waitcnt lgkmcnt(14)
    v_mfma_f32_16x16x32_bf16 v[40:43], v[48:51], v[104:107], 0
    s_waitcnt lgkmcnt(13)
    v_mfma_f32_16x16x32_bf16 v[36:39], v[48:51], v[100:103], 0
    s_waitcnt lgkmcnt(12)
    v_mfma_f32_16x16x32_bf16 v[32:35], v[48:51], v[96:99], 0
    s_waitcnt lgkmcnt(11)
    v_mfma_f32_16x16x32_bf16 v[28:31], v[48:51], v[92:95], 0
    s_waitcnt lgkmcnt(10)
    v_mfma_f32_16x16x32_bf16 v[24:27], v[48:51], v[88:91], 0
    s_add_u32 m0, s74, 6144
    s_add_u32 s68, s70, 172032
    buffer_load_dwordx4 v252, s[28:31], s68 offen lds
    s_waitcnt lgkmcnt(9)
    v_mfma_f32_16x16x32_bf16 v[20:23], v[48:51], v[84:87], 0
    s_waitcnt lgkmcnt(8)
    v_mfma_f32_16x16x32_bf16 v[16:19], v[48:51], v[80:83], 0
    ds_read_b128 v[48:51], v168 offset:64
    s_waitcnt lgkmcnt(8)
    v_mfma_f32_16x16x32_bf16 v[44:47], v[52:55], v[104:107], v[44:47]
    ds_read_b128 v[104:107], v169 offset:3200
    v_mfma_f32_16x16x32_bf16 v[40:43], v[52:55], v[100:103], v[40:43]
    v_mfma_f32_16x16x32_bf16 v[36:39], v[52:55], v[96:99], v[36:39]
    buffer_load_dwordx4 v253, s[28:31], s68 offen offset:1024 lds
    v_mfma_f32_16x16x32_bf16 v[32:35], v[52:55], v[92:95], v[32:35]
    v_mfma_f32_16x16x32_bf16 v[28:31], v[52:55], v[88:91], v[28:31]
    v_mfma_f32_16x16x32_bf16 v[24:27], v[52:55], v[84:87], v[24:27]
    v_mfma_f32_16x16x32_bf16 v[20:23], v[52:55], v[80:83], v[20:23]
    ds_read_b128 v[52:55], v168 offset:576
    s_waitcnt lgkmcnt(9)
    v_mfma_f32_16x16x32_bf16 v[44:47], v[56:59], v[100:103], v[44:47]
    ds_read_b128 v[100:103], v169 offset:2688
    v_mfma_f32_16x16x32_bf16 v[40:43], v[56:59], v[96:99], v[40:43]
    s_add_u32 m0, s74, 8192
    s_add_u32 s68, s70, 229376
    buffer_load_dwordx4 v252, s[28:31], s68 offen lds
    v_mfma_f32_16x16x32_bf16 v[36:39], v[56:59], v[92:95], v[36:39]
    v_mfma_f32_16x16x32_bf16 v[32:35], v[56:59], v[88:91], v[32:35]
    v_mfma_f32_16x16x32_bf16 v[28:31], v[56:59], v[84:87], v[28:31]
    v_mfma_f32_16x16x32_bf16 v[24:27], v[56:59], v[80:83], v[24:27]
    ds_read_b128 v[56:59], v168 offset:1088
    s_waitcnt lgkmcnt(10)
    v_mfma_f32_16x16x32_bf16 v[44:47], v[60:63], v[96:99], v[44:47]
    ds_read_b128 v[96:99], v169 offset:2176
    buffer_load_dwordx4 v253, s[28:31], s68 offen offset:1024 lds
    v_mfma_f32_16x16x32_bf16 v[40:43], v[60:63], v[92:95], v[40:43]
    v_mfma_f32_16x16x32_bf16 v[36:39], v[60:63], v[88:91], v[36:39]
    buffer_load_dword v160, v178, s[48:51], 0 offen sc1
    v_mfma_f32_16x16x32_bf16 v[32:35], v[60:63], v[84:87], v[32:35]
    v_mfma_f32_16x16x32_bf16 v[28:31], v[60:63], v[80:83], v[28:31]
    ds_read_b128 v[60:63], v168 offset:1600
    s_waitcnt lgkmcnt(11)
    v_mfma_f32_16x16x32_bf16 v[44:47], v[64:67], v[92:95], v[44:47]
    ds_read_b128 v[92:95], v169 offset:1664
    v_mfma_f32_16x16x32_bf16 v[40:43], v[64:67], v[88:91], v[40:43]
    v_mfma_f32_16x16x32_bf16 v[36:39], v[64:67], v[84:87], v[36:39]
    s_add_u32 m0, s74, 10240
    s_add_u32 s68, s70, 286720
    buffer_load_dwordx4 v252, s[28:31], s68 offen lds
    v_mfma_f32_16x16x32_bf16 v[32:35], v[64:67], v[80:83], v[32:35]
    ds_read_b128 v[64:67], v168 offset:2112
    s_waitcnt lgkmcnt(12)
    v_mfma_f32_16x16x32_bf16 v[44:47], v[68:71], v[88:91], v[44:47]
    ds_read_b128 v[88:91], v169 offset:1152
    v_mfma_f32_16x16x32_bf16 v[40:43], v[68:71], v[84:87], v[40:43]
    v_mfma_f32_16x16x32_bf16 v[36:39], v[68:71], v[80:83], v[36:39]
    ds_read_b128 v[68:71], v168 offset:2624
    s_waitcnt lgkmcnt(13)
    v_mfma_f32_16x16x32_bf16 v[44:47], v[72:75], v[84:87], v[44:47]
    ds_read_b128 v[84:87], v169 offset:640
    buffer_load_dwordx4 v253, s[28:31], s68 offen offset:1024 lds
    v_mfma_f32_16x16x32_bf16 v[40:43], v[72:75], v[80:83], v[40:43]
    ds_read_b128 v[72:75], v168 offset:3136
    s_waitcnt lgkmcnt(14)
    v_mfma_f32_16x16x32_bf16 v[44:47], v[76:79], v[80:83], v[44:47]
    ds_read_b128 v[80:83], v169 offset:128
    ds_read_b128 v[76:79], v168 offset:3648
    s_waitcnt lgkmcnt(14)
    v_mfma_f32_16x16x32_bf16 v[44:47], v[48:51], v[108:111], v[44:47]
    ds_read_b128 v[108:111], v169 offset:3648
    s_waitcnt lgkmcnt(14)
    v_mfma_f32_16x16x32_bf16 v[40:43], v[48:51], v[104:107], v[40:43]
    s_waitcnt lgkmcnt(12)
    v_mfma_f32_16x16x32_bf16 v[36:39], v[48:51], v[100:103], v[36:39]
    s_add_u32 m0, s74, 12288
    s_add_u32 s68, s70, 344064
    buffer_load_dwordx4 v252, s[28:31], s68 offen lds
    s_waitcnt lgkmcnt(10)
    v_mfma_f32_16x16x32_bf16 v[32:35], v[48:51], v[96:99], v[32:35]
    s_waitcnt lgkmcnt(8)
    v_mfma_f32_16x16x32_bf16 v[28:31], v[48:51], v[92:95], v[28:31]
    s_waitcnt lgkmcnt(6)
    v_mfma_f32_16x16x32_bf16 v[24:27], v[48:51], v[88:91], v[24:27]
    s_waitcnt lgkmcnt(4)
    v_mfma_f32_16x16x32_bf16 v[20:23], v[48:51], v[84:87], v[20:23]
    s_waitcnt lgkmcnt(2)
    v_mfma_f32_16x16x32_bf16 v[16:19], v[48:51], v[80:83], v[16:19]
    ds_read_b128 v[48:51], v168 offset:128
    buffer_load_dwordx4 v253, s[28:31], s68 offen offset:1024 lds
    v_mfma_f32_16x16x32_bf16 v[44:47], v[52:55], v[104:107], v[44:47]
    ds_read_b128 v[104:107], v169 offset:3136
    v_mfma_f32_16x16x32_bf16 v[40:43], v[52:55], v[100:103], v[40:43]
    v_mfma_f32_16x16x32_bf16 v[36:39], v[52:55], v[96:99], v[36:39]
    v_mfma_f32_16x16x32_bf16 v[32:35], v[52:55], v[92:95], v[32:35]
    v_mfma_f32_16x16x32_bf16 v[28:31], v[52:55], v[88:91], v[28:31]
    s_add_u32 m0, s75, 0
    s_add_u32 s68, s71, 0
    buffer_load_dwordx4 v252, s[28:31], s68 offen lds
    v_mfma_f32_16x16x32_bf16 v[24:27], v[52:55], v[84:87], v[24:27]
    v_mfma_f32_16x16x32_bf16 v[20:23], v[52:55], v[80:83], v[20:23]
    ds_read_b128 v[52:55], v168 offset:640
    v_mfma_f32_16x16x32_bf16 v[44:47], v[56:59], v[100:103], v[44:47]
    ds_read_b128 v[100:103], v169 offset:2624
    v_mfma_f32_16x16x32_bf16 v[40:43], v[56:59], v[96:99], v[40:43]
    v_mfma_f32_16x16x32_bf16 v[36:39], v[56:59], v[92:95], v[36:39]
    buffer_load_dwordx4 v253, s[28:31], s68 offen offset:1024 lds
    v_mfma_f32_16x16x32_bf16 v[32:35], v[56:59], v[88:91], v[32:35]
    v_mfma_f32_16x16x32_bf16 v[28:31], v[56:59], v[84:87], v[28:31]
    v_mfma_f32_16x16x32_bf16 v[24:27], v[56:59], v[80:83], v[24:27]
    ds_read_b128 v[56:59], v168 offset:1152
    v_mfma_f32_16x16x32_bf16 v[44:47], v[60:63], v[96:99], v[44:47]
    ds_read_b128 v[96:99], v169 offset:2112
    v_mfma_f32_16x16x32_bf16 v[40:43], v[60:63], v[92:95], v[40:43]
    s_waitcnt vmcnt(6)
    v_cmp_ne_u32_e64 vcc, s57, v160
    s_cbranch_vccz polld_14
    s_mov_b32 s69, 1000000
poll_13:
    buffer_load_dword v160, v178, s[48:51], s59 offen sc1
    s_waitcnt vmcnt(0)
    v_cmp_ne_u32 vcc, s57, v160
    s_cbranch_vccz polld_14
    s_sub_u32 s69, s69, 1
    s_cbranch_scc0 poll_13
polld_14:
    v_mfma_f32_16x16x32_bf16 v[36:39], v[60:63], v[88:91], v[36:39]
    buffer_load_dwordx2 v[150:151], v171, s[48:51], 0 offen offset:1024 sc1
    v_mfma_f32_16x16x32_bf16 v[32:35], v[60:63], v[84:87], v[32:35]
    v_mfma_f32_16x16x32_bf16 v[28:31], v[60:63], v[80:83], v[28:31]
    ds_read_b128 v[60:63], v168 offset:1664
    buffer_load_dwordx4 v[124:127], v173, s[48:51], 0 offen offset:2048
    v_mfma_f32_16x16x32_bf16 v[44:47], v[64:67], v[92:95], v[44:47]
    ds_read_b128 v[92:95], v169 offset:1600
    v_mfma_f32_16x16x32_bf16 v[40:43], v[64:67], v[88:91], v[40:43]
    v_mfma_f32_16x16x32_bf16 v[36:39], v[64:67], v[84:87], v[36:39]
    buffer_load_dwordx4 v[140:143], v173, s[48:51], s61 offen offset:2048
    v_mfma_f32_16x16x32_bf16 v[32:35], v[64:67], v[80:83], v[32:35]
    ds_read_b128 v[64:67], v168 offset:2176
    v_mfma_f32_16x16x32_bf16 v[44:47], v[68:71], v[88:91], v[44:47]
    ds_read_b128 v[88:91], v169 offset:1088
    buffer_load_dwordx2 v[148:149], v171, s[48:51], 0 offen offset:0 sc1
    v_mfma_f32_16x16x32_bf16 v[40:43], v[68:71], v[84:87], v[40:43]
    v_mfma_f32_16x16x32_bf16 v[36:39], v[68:71], v[80:83], v[36:39]
    ds_read_b128 v[68:71], v168 offset:2688
    buffer_load_dwordx4 v[120:123], v173, s[48:51], 0 offen offset:0
    v_mfma_f32_16x16x32_bf16 v[44:47], v[72:75], v[84:87], v[44:47]
    ds_read_b128 v[84:87], v169 offset:576
    v_mfma_f32_16x16x32_bf16 v[40:43], v[72:75], v[80:83], v[40:43]
    ds_read_b128 v[72:75], v168 offset:3200
    s_waitcnt lgkmcnt(14)
    v_mfma_f32_16x16x32_bf16 v[44:47], v[76:79], v[80:83], v[44:47]
    ds_read_b128 v[80:83], v169 offset:64
    ds_read_b128 v[76:79], v168 offset:3712
    s_waitcnt lgkmcnt(14)
    v_mfma_f32_16x16x32_bf16 v[44:47], v[48:51], v[108:111], v[44:47]
    ds_read_b128 v[108:111], v169 offset:3584
    buffer_load_dwordx4 v[136:139], v173, s[48:51], s61 offen offset:0
    s_waitcnt lgkmcnt(14)
    v_mfma_f32_16x16x32_bf16 v[40:43], v[48:51], v[104:107], v[40:43]
    s_waitcnt lgkmcnt(12)
    v_mfma_f32_16x16x32_bf16 v[36:39], v[48:51], v[100:103], v[36:39]
    buffer_load_dwordx2 v[146:147], v170, s[48:51], 0 offen offset:1024 sc1
    s_waitcnt lgkmcnt(10)
    v_mfma_f32_16x16x32_bf16 v[32:35], v[48:51], v[96:99], v[32:35]
    s_waitcnt lgkmcnt(8)
    v_mfma_f32_16x16x32_bf16 v[28:31], v[48:51], v[92:95], v[28:31]
    buffer_load_dwordx4 v[116:119], v172, s[48:51], 0 offen offset:2048
    s_waitcnt lgkmcnt(6)
    v_mfma_f32_16x16x32_bf16 v[24:27], v[48:51], v[88:91], v[24:27]
    s_waitcnt lgkmcnt(4)
    v_mfma_f32_16x16x32_bf16 v[20:23], v[48:51], v[84:87], v[20:23]
    buffer_load_dwordx4 v[132:135], v172, s[48:51], s61 offen offset:2048
    s_waitcnt lgkmcnt(2)
    v_mfma_f32_16x16x32_bf16 v[16:19], v[48:51], v[80:83], v[16:19]
    ds_read_b128 v[48:51], v168 offset:192
    v_mfma_f32_16x16x32_bf16 v[44:47], v[52:55], v[104:107], v[44:47]
    ds_read_b128 v[104:107], v169 offset:3072
    buffer_load_dwordx2 v[144:145], v170, s[48:51], 0 offen offset:0 sc1
    v_mfma_f32_16x16x32_bf16 v[40:43], v[52:55], v[100:103], v[40:43]
    v_mfma_f32_16x16x32_bf16 v[36:39], v[52:55], v[96:99], v[36:39]
    buffer_load_dwordx4 v[112:115], v172, s[48:51], 0 offen offset:0
    v_mfma_f32_16x16x32_bf16 v[32:35], v[52:55], v[92:95], v[32:35]
    v_mfma_f32_16x16x32_bf16 v[28:31], v[52:55], v[88:91], v[28:31]
    buffer_load_dwordx4 v[128:131], v172, s[48:51], s61 offen offset:0
    v_mfma_f32_16x16x32_bf16 v[24:27], v[52:55], v[84:87], v[24:27]
    v_mfma_f32_16x16x32_bf16 v[20:23], v[52:55], v[80:83], v[20:23]
    ds_read_b128 v[52:55], v168 offset:704
    v_mfma_f32_16x16x32_bf16 v[44:47], v[56:59], v[100:103], v[44:47]
    ds_read_b128 v[100:103], v169 offset:2560
    v_mfma_f32_16x16x32_bf16 v[40:43], v[56:59], v[96:99], v[40:43]
    v_mfma_f32_16x16x32_bf16 v[36:39], v[56:59], v[92:95], v[36:39]
    s_add_u32 m0, s75, 2048
    s_add_u32 s68, s71, 57344
    buffer_load_dwordx4 v252, s[28:31], s68 offen lds
    v_mfma_f32_16x16x32_bf16 v[32:35], v[56:59], v[88:91], v[32:35]
    v_mfma_f32_16x16x32_bf16 v[28:31], v[56:59], v[84:87], v[28:31]
    v_mfma_f32_16x16x32_bf16 v[24:27], v[56:59], v[80:83], v[24:27]
    ds_read_b128 v[56:59], v168 offset:1216
    v_mfma_f32_16x16x32_bf16 v[44:47], v[60:63], v[96:99], v[44:47]
    ds_read_b128 v[96:99], v169 offset:2048
    v_mfma_f32_16x16x32_bf16 v[40:43], v[60:63], v[92:95], v[40:43]
    buffer_load_dwordx4 v253, s[28:31], s68 offen offset:1024 lds
    v_mfma_f32_16x16x32_bf16 v[36:39], v[60:63], v[88:91], v[36:39]
    v_mfma_f32_16x16x32_bf16 v[32:35], v[60:63], v[84:87], v[32:35]
    v_mfma_f32_16x16x32_bf16 v[28:31], v[60:63], v[80:83], v[28:31]
    ds_read_b128 v[60:63], v168 offset:1728
    v_mfma_f32_16x16x32_bf16 v[44:47], v[64:67], v[92:95], v[44:47]
    ds_read_b128 v[92:95], v169 offset:1536
    v_mfma_f32_16x16x32_bf16 v[40:43], v[64:67], v[88:91], v[40:43]
    s_add_u32 m0, s75, 4096
    s_add_u32 s68, s71, 114688
    buffer_load_dwordx4 v252, s[28:31], s68 offen lds
    v_mfma_f32_16x16x32_bf16 v[36:39], v[64:67], v[84:87], v[36:39]
    v_mfma_f32_16x16x32_bf16 v[32:35], v[64:67], v[80:83], v[32:35]
    ds_read_b128 v[64:67], v168 offset:2240
    v_mfma_f32_16x16x32_bf16 v[44:47], v[68:71], v[88:91], v[44:47]
    ds_read_b128 v[88:91], v169 offset:1024
    v_mfma_f32_16x16x32_bf16 v[40:43], v[68:71], v[84:87], v[40:43]
    v_mfma_f32_16x16x32_bf16 v[36:39], v[68:71], v[80:83], v[36:39]
    ds_read_b128 v[68:71], v168 offset:2752
    buffer_load_dwordx4 v253, s[28:31], s68 offen offset:1024 lds
    v_mfma_f32_16x16x32_bf16 v[44:47], v[72:75], v[84:87], v[44:47]
    ds_read_b128 v[84:87], v169 offset:512
    v_mfma_f32_16x16x32_bf16 v[40:43], v[72:75], v[80:83], v[40:43]
    ds_read_b128 v[72:75], v168 offset:3264
    s_waitcnt lgkmcnt(14)
    v_mfma_f32_16x16x32_bf16 v[44:47], v[76:79], v[80:83], v[44:47]
    ds_read_b128 v[80:83], v169 offset:0
    ds_read_b128 v[76:79], v168 offset:3776
    v_xor_b32 v164, 0x1000, v174
    s_mul_i32 s75, s54, 10240
    s_add_u32 s75, s75, 57344
    v_add_u32 v238, s75, v250
    v_xor_b32_e64 v239, 64, v238
    s_cmp_lg_u32 s65, 0
    s_cbranch_scc1 convh1_15
    s_waitcnt lgkmcnt(13)
    v_mfma_f32_16x16x32_bf16 v[40:43], v[48:51], v[104:107], v[40:43]
    s_waitcnt lgkmcnt(9)
    v_mfma_f32_16x16x32_bf16 v[32:35], v[48:51], v[96:99], v[32:35]
    v_mfma_f32_16x16x32_bf16 v[40:43], v[52:55], v[100:103], v[40:43]
    s_waitcnt lgkmcnt(7)
    v_mfma_f32_16x16x32_bf16 v[32:35], v[52:55], v[92:95], v[32:35]
    v_mfma_f32_16x16x32_bf16 v[40:43], v[56:59], v[96:99], v[40:43]
    s_waitcnt lgkmcnt(5)
    v_mfma_f32_16x16x32_bf16 v[32:35], v[56:59], v[88:91], v[32:35]
    v_mfma_f32_16x16x32_bf16 v[40:43], v[60:63], v[92:95], v[40:43]
    s_waitcnt lgkmcnt(3)
    v_mfma_f32_16x16x32_bf16 v[32:35], v[60:63], v[84:87], v[32:35]
    v_mfma_f32_16x16x32_bf16 v[40:43], v[64:67], v[88:91], v[40:43]
    s_waitcnt lgkmcnt(1)
    v_mfma_f32_16x16x32_bf16 v[32:35], v[64:67], v[80:83], v[32:35]
    s_waitcnt lgkmcnt(0)
    s_barrier
    v_mfma_f32_16x16x32_bf16 v[40:43], v[68:71], v[84:87], v[40:43]
    v_mfma_f32_16x16x32_bf16 v[28:31], v[48:51], v[92:95], v[28:31]
    v_mfma_f32_16x16x32_bf16 v[40:43], v[72:75], v[80:83], v[40:43]
    s_nop 2
    ds_write_b128 v174, v[32:35] offset:2048
    v_mfma_f32_16x16x32_bf16 v[28:31], v[52:55], v[88:91], v[28:31]
    v_mfma_f32_16x16x32_bf16 v[20:23], v[48:51], v[84:87], v[20:23]
    v_mfma_f32_16x16x32_bf16 v[28:31], v[56:59], v[84:87], v[28:31]
    s_nop 0
    ds_write_b128 v174, v[40:43] offset:3072
    v_mfma_f32_16x16x32_bf16 v[20:23], v[52:55], v[80:83], v[20:23]
    v_mfma_f32_16x16x32_bf16 v[28:31], v[60:63], v[80:83], v[28:31]
    v_mfma_f32_16x16x32_bf16 v[44:47], v[48:51], v[108:111], v[44:47]
    v_mfma_f32_16x16x32_bf16 v[36:39], v[48:51], v[100:103], v[36:39]
    s_nop 4
    ds_write_b128 v174, v[20:23] offset:0
    v_mfma_f32_16x16x32_bf16 v[44:47], v[52:55], v[104:107], v[44:47]
    ds_write_b128 v174, v[28:31] offset:1024
    v_mfma_f32_16x16x32_bf16 v[36:39], v[52:55], v[96:99], v[36:39]
    s_waitcnt vmcnt(15)
    v_lshlrev_b32 v196, 16, v150
    s_waitcnt vmcnt(13)
    v_fma_f32 v124, v196, v124, v140
    v_mfma_f32_16x16x32_bf16 v[44:47], v[56:59], v[100:103], v[44:47]
    v_and_b32 v197, 0xffff0000, v150
    v_fma_f32 v125, v197, v125, v141
    v_mfma_f32_16x16x32_bf16 v[36:39], v[56:59], v[92:95], v[36:39]
    s_waitcnt lgkmcnt(0)
    s_barrier
    v_mfma_f32_16x16x32_bf16 v[44:47], v[60:63], v[96:99], v[44:47]
    ds_read_b128 v[218:221], v164 offset:3072
    ds_read_b128 v[214:217], v164 offset:2048
    v_mfma_f32_16x16x32_bf16 v[36:39], v[60:63], v[88:91], v[36:39]
    ds_read_b128 v[210:213], v164 offset:1024
    ds_read_b128 v[206:209], v164 offset:0
    v_mfma_f32_16x16x32_bf16 v[44:47], v[64:67], v[92:95], v[44:47]
    v_lshlrev_b32_e64 v198, 16, v151
    v_fma_f32 v126, v198, v126, v142
    v_mfma_f32_16x16x32_bf16 v[36:39], v[64:67], v[84:87], v[36:39]
    v_and_b32 v199, 0xffff0000, v151
    v_fma_f32 v127, v199, v127, v143
    v_mfma_f32_16x16x32_bf16 v[44:47], v[68:71], v[88:91], v[44:47]
    s_waitcnt vmcnt(12)
    v_lshlrev_b32_e64 v192, 16, v148
    s_waitcnt vmcnt(10)
    v_fma_f32 v120, v192, v120, v136
    v_mfma_f32_16x16x32_bf16 v[36:39], v[68:71], v[80:83], v[36:39]
    v_and_b32 v193, 0xffff0000, v148
    v_fma_f32 v121, v193, v121, v137
    v_mfma_f32_16x16x32_bf16 v[44:47], v[72:75], v[84:87], v[44:47]
    v_lshlrev_b32_e64 v194, 16, v149
    v_fma_f32 v122, v194, v122, v138
    v_mfma_f32_16x16x32_bf16 v[24:27], v[48:51], v[88:91], v[24:27]
    v_and_b32 v195, 0xffff0000, v149
    v_fma_f32 v123, v195, v123, v139
    v_mfma_f32_16x16x32_bf16 v[44:47], v[76:79], v[80:83], v[44:47]
    s_waitcnt vmcnt(9)
    v_lshlrev_b32_e64 v188, 16, v146
    s_waitcnt vmcnt(7)
    v_fma_f32 v116, v188, v116, v132
    v_mfma_f32_16x16x32_bf16 v[24:27], v[52:55], v[84:87], v[24:27]
    v_and_b32 v189, 0xffff0000, v146
    v_fma_f32 v117, v189, v117, v133
    v_mfma_f32_16x16x32_bf16 v[16:19], v[48:51], v[80:83], v[16:19]
    v_lshlrev_b32_e64 v190, 16, v147
    v_fma_f32 v118, v190, v118, v134
    v_mfma_f32_16x16x32_bf16 v[24:27], v[56:59], v[80:83], v[24:27]
    v_and_b32 v191, 0xffff0000, v147
    v_fma_f32 v119, v191, v119, v135
    s_waitcnt vmcnt(6)
    v_lshlrev_b32 v184, 16, v144
    v_and_b32 v185, 0xffff0000, v144
    v_lshlrev_b32 v186, 16, v145
    v_and_b32 v187, 0xffff0000, v145
    s_waitcnt vmcnt(4)
    v_pk_fma_f32 v[112:113], v[184:185], v[112:113], v[128:129]
    v_pk_fma_f32 v[114:115], v[186:187], v[114:115], v[130:131]
    s_waitcnt lgkmcnt(3)
    v_pk_fma_f32 v[196:197], v[124:125], v[218:219], v[196:197]
    v_pk_fma_f32 v[198:199], v[126:127], v[220:221], v[198:199]
    s_waitcnt lgkmcnt(2)
    v_pk_fma_f32 v[192:193], v[120:121], v[214:215], v[192:193]
    v_pk_fma_f32 v[194:195], v[122:123], v[216:217], v[194:195]
    v_pk_fma_f32 v[192:193], v[120:121], v[36:37], v[192:193]
    v_pk_fma_f32 v[194:195], v[122:123], v[38:39], v[194:195]
    v_pk_fma_f32 v[196:197], v[124:125], v[44:45], v[196:197]
    v_pk_fma_f32 v[198:199], v[126:127], v[46:47], v[198:199]
    v_cvt_pk_bf16_f32 v228, v196, v197
    v_cvt_pk_bf16_f32 v229, v198, v199
    v_cvt_pk_bf16_f32 v226, v192, v193
    v_cvt_pk_bf16_f32 v227, v194, v195
    s_nop 0
    v_permlane16_swap_b32 v226, v228
    v_permlane16_swap_b32 v227, v229
    buffer_store_dwordx4 v[226:229], v176, s[48:51], 0 offen sc1
    s_waitcnt lgkmcnt(1)
    v_pk_fma_f32 v[188:189], v[116:117], v[210:211], v[188:189]
    v_pk_fma_f32 v[190:191], v[118:119], v[212:213], v[190:191]
    s_waitcnt lgkmcnt(0)
    v_pk_fma_f32 v[184:185], v[112:113], v[206:207], v[184:185]
    v_pk_fma_f32 v[186:187], v[114:115], v[208:209], v[186:187]
    v_pk_fma_f32 v[184:185], v[112:113], v[16:17], v[184:185]
    v_pk_fma_f32 v[186:187], v[114:115], v[18:19], v[186:187]
    v_pk_fma_f32 v[188:189], v[116:117], v[24:25], v[188:189]
    v_pk_fma_f32 v[190:191], v[118:119], v[26:27], v[190:191]
    v_cvt_pk_bf16_f32 v224, v188, v189
    v_cvt_pk_bf16_f32 v225, v190, v191
    v_cvt_pk_bf16_f32 v222, v184, v185
    v_cvt_pk_bf16_f32 v223, v186, v187
    s_nop 0
    v_permlane16_swap_b32 v222, v224
    v_permlane16_swap_b32 v223, v225
    buffer_store_dwordx4 v[222:225], v175, s[48:51], 0 offen sc1
    s_branch convd_16
convh1_15:
    s_waitcnt lgkmcnt(14)
    v_mfma_f32_16x16x32_bf16 v[44:47], v[48:51], v[108:111], v[44:47]
    s_waitcnt lgkmcnt(11)
    v_mfma_f32_16x16x32_bf16 v[36:39], v[48:51], v[100:103], v[36:39]
    v_mfma_f32_16x16x32_bf16 v[44:47], v[52:55], v[104:107], v[44:47]
    s_waitcnt lgkmcnt(9)
    v_mfma_f32_16x16x32_bf16 v[36:39], v[52:55], v[96:99], v[36:39]
    v_mfma_f32_16x16x32_bf16 v[44:47], v[56:59], v[100:103], v[44:47]
    s_waitcnt lgkmcnt(7)
    v_mfma_f32_16x16x32_bf16 v[36:39], v[56:59], v[92:95], v[36:39]
    v_mfma_f32_16x16x32_bf16 v[44:47], v[60:63], v[96:99], v[44:47]
    s_waitcnt lgkmcnt(5)
    v_mfma_f32_16x16x32_bf16 v[36:39], v[60:63], v[88:91], v[36:39]
    v_mfma_f32_16x16x32_bf16 v[44:47], v[64:67], v[92:95], v[44:47]
    s_waitcnt lgkmcnt(3)
    v_mfma_f32_16x16x32_bf16 v[36:39], v[64:67], v[84:87], v[36:39]
    s_waitcnt lgkmcnt(0)
    s_barrier
    v_mfma_f32_16x16x32_bf16 v[44:47], v[68:71], v[88:91], v[44:47]
    v_mfma_f32_16x16x32_bf16 v[36:39], v[68:71], v[80:83], v[36:39]
    v_mfma_f32_16x16x32_bf16 v[44:47], v[72:75], v[84:87], v[44:47]
    v_mfma_f32_16x16x32_bf16 v[24:27], v[48:51], v[88:91], v[24:27]
    v_mfma_f32_16x16x32_bf16 v[44:47], v[76:79], v[80:83], v[44:47]
    s_nop 4
    ds_write_b128 v174, v[36:39] offset:2048
    v_mfma_f32_16x16x32_bf16 v[24:27], v[52:55], v[84:87], v[24:27]
    v_mfma_f32_16x16x32_bf16 v[16:19], v[48:51], v[80:83], v[16:19]
    v_mfma_f32_16x16x32_bf16 v[24:27], v[56:59], v[80:83], v[24:27]
    ds_write_b128 v174, v[44:47] offset:3072
    v_mfma_f32_16x16x32_bf16 v[40:43], v[48:51], v[104:107], v[40:43]
    v_mfma_f32_16x16x32_bf16 v[32:35], v[48:51], v[96:99], v[32:35]
    s_nop 3
    ds_write_b128 v174, v[16:19] offset:0
    v_mfma_f32_16x16x32_bf16 v[40:43], v[52:55], v[100:103], v[40:43]
    ds_write_b128 v174, v[24:27] offset:1024
    v_mfma_f32_16x16x32_bf16 v[32:35], v[52:55], v[92:95], v[32:35]
    s_waitcnt vmcnt(15)
    v_lshlrev_b32 v196, 16, v150
    s_waitcnt vmcnt(13)
    v_fma_f32 v124, v196, v124, v140
    v_mfma_f32_16x16x32_bf16 v[40:43], v[56:59], v[96:99], v[40:43]
    v_and_b32 v197, 0xffff0000, v150
    v_fma_f32 v125, v197, v125, v141
    v_mfma_f32_16x16x32_bf16 v[32:35], v[56:59], v[88:91], v[32:35]
    s_waitcnt lgkmcnt(0)
    s_barrier
    v_mfma_f32_16x16x32_bf16 v[40:43], v[60:63], v[92:95], v[40:43]
    ds_read_b128 v[218:221], v164 offset:3072
    ds_read_b128 v[214:217], v164 offset:2048
    v_mfma_f32_16x16x32_bf16 v[32:35], v[60:63], v[84:87], v[32:35]
    ds_read_b128 v[210:213], v164 offset:1024
    ds_read_b128 v[206:209], v164 offset:0
    v_mfma_f32_16x16x32_bf16 v[40:43], v[64:67], v[88:91], v[40:43]
    v_lshlrev_b32_e64 v198, 16, v151
    v_fma_f32 v126, v198, v126, v142
    v_mfma_f32_16x16x32_bf16 v[32:35], v[64:67], v[80:83], v[32:35]
    v_and_b32 v199, 0xffff0000, v151
    v_fma_f32 v127, v199, v127, v143
    v_mfma_f32_16x16x32_bf16 v[40:43], v[68:71], v[84:87], v[40:43]
    s_waitcnt vmcnt(12)
    v_lshlrev_b32_e64 v192, 16, v148
    s_waitcnt vmcnt(10)
    v_fma_f32 v120, v192, v120, v136
    v_mfma_f32_16x16x32_bf16 v[28:31], v[48:51], v[92:95], v[28:31]
    v_and_b32 v193, 0xffff0000, v148
    v_fma_f32 v121, v193, v121, v137
    v_mfma_f32_16x16x32_bf16 v[40:43], v[72:75], v[80:83], v[40:43]
    v_lshlrev_b32_e64 v194, 16, v149
    v_fma_f32 v122, v194, v122, v138
    v_mfma_f32_16x16x32_bf16 v[28:31], v[52:55], v[88:91], v[28:31]
    v_and_b32 v195, 0xffff0000, v149
    v_fma_f32 v123, v195, v123, v139
    v_mfma_f32_16x16x32_bf16 v[20:23], v[48:51], v[84:87], v[20:23]
    s_waitcnt vmcnt(9)
    v_lshlrev_b32_e64 v188, 16, v146
    s_waitcnt vmcnt(7)
    v_fma_f32 v116, v188, v116, v132
    v_mfma_f32_16x16x32_bf16 v[28:31], v[56:59], v[84:87], v[28:31]
    v_and_b32 v189, 0xffff0000, v146
    v_fma_f32 v117, v189, v117, v133
    v_mfma_f32_16x16x32_bf16 v[20:23], v[52:55], v[80:83], v[20:23]
    v_lshlrev_b32_e64 v190, 16, v147
    v_fma_f32 v118, v190, v118, v134
    v_mfma_f32_16x16x32_bf16 v[28:31], v[60:63], v[80:83], v[28:31]
    v_and_b32 v191, 0xffff0000, v147
    v_fma_f32 v119, v191, v119, v135
    s_waitcnt vmcnt(6)
    v_lshlrev_b32 v184, 16, v144
    v_and_b32 v185, 0xffff0000, v144
    v_lshlrev_b32_e64 v186, 16, v145
    v_and_b32 v187, 0xffff0000, v145
    s_waitcnt vmcnt(4)
    v_pk_fma_f32 v[112:113], v[184:185], v[112:113], v[128:129]
    v_pk_fma_f32 v[114:115], v[186:187], v[114:115], v[130:131]
    s_waitcnt lgkmcnt(3)
    v_pk_fma_f32 v[196:197], v[124:125], v[218:219], v[196:197]
    v_pk_fma_f32 v[198:199], v[126:127], v[220:221], v[198:199]
    s_waitcnt lgkmcnt(2)
    v_pk_fma_f32 v[192:193], v[120:121], v[214:215], v[192:193]
    v_pk_fma_f32 v[194:195], v[122:123], v[216:217], v[194:195]
    v_pk_fma_f32 v[192:193], v[120:121], v[32:33], v[192:193]
    v_pk_fma_f32 v[194:195], v[122:123], v[34:35], v[194:195]
    v_pk_fma_f32 v[196:197], v[124:125], v[40:41], v[196:197]
    v_pk_fma_f32 v[198:199], v[126:127], v[42:43], v[198:199]
    v_cvt_pk_bf16_f32 v228, v196, v197
    v_cvt_pk_bf16_f32 v229, v198, v199
    v_cvt_pk_bf16_f32 v226, v192, v193
    v_cvt_pk_bf16_f32 v227, v194, v195
    s_nop 0
    v_permlane16_swap_b32 v226, v228
    v_permlane16_swap_b32 v227, v229
    buffer_store_dwordx4 v[226:229], v176, s[48:51], 0 offen sc1
    s_waitcnt lgkmcnt(1)
    v_pk_fma_f32 v[188:189], v[116:117], v[210:211], v[188:189]
    v_pk_fma_f32 v[190:191], v[118:119], v[212:213], v[190:191]
    s_waitcnt lgkmcnt(0)
    v_pk_fma_f32 v[184:185], v[112:113], v[206:207], v[184:185]
    v_pk_fma_f32 v[186:187], v[114:115], v[208:209], v[186:187]
    v_pk_fma_f32 v[184:185], v[112:113], v[20:21], v[184:185]
    v_pk_fma_f32 v[186:187], v[114:115], v[22:23], v[186:187]
    v_pk_fma_f32 v[188:189], v[116:117], v[28:29], v[188:189]
    v_pk_fma_f32 v[190:191], v[118:119], v[30:31], v[190:191]
    v_cvt_pk_bf16_f32 v224, v188, v189
    v_cvt_pk_bf16_f32 v225, v190, v191
    v_cvt_pk_bf16_f32 v222, v184, v185
    v_cvt_pk_bf16_f32 v223, v186, v187
    s_nop 0
    v_permlane16_swap_b32 v222, v224
    s_branch SKIP2
PAD2:
    s_branch PAD6
SKIP2:
    v_permlane16_swap_b32 v223, v225
    buffer_store_dwordx4 v[222:225], v175, s[48:51], 0 offen sc1
convd_16:
    ds_read_b64_tr_b16 a[8:9], v248 offset:2048
    ds_read_b64_tr_b16 a[10:11], v248 offset:3072
    ds_read_b64_tr_b16 a[12:13], v249 offset:2048
    ds_read_b64_tr_b16 a[14:15], v249 offset:3072
    ds_read_b64_tr_b16 a[16:17], v248 offset:4096
    ds_read_b64_tr_b16 a[18:19], v248 offset:5120
    s_add_u32 m0, s75, 0
    s_add_u32 s68, s71, 172032
    buffer_load_dwordx4 v252, s[28:31], s68 offen lds
    ds_read_b64_tr_b16 a[20:21], v249 offset:4096
    ds_read_b64_tr_b16 a[22:23], v249 offset:5120
    ds_read_b64_tr_b16 a[24:25], v248 offset:6144
    buffer_load_dwordx4 v253, s[28:31], s68 offen offset:1024 lds
    ds_read_b64_tr_b16 a[26:27], v248 offset:7168
    ds_read_b64_tr_b16 a[28:29], v249 offset:6144
    ds_read_b64_tr_b16 a[30:31], v249 offset:7168
    ds_read_b64_tr_b16 a[32:33], v248 offset:8192
    ds_read_b64_tr_b16 a[34:35], v248 offset:9216
    ds_read_b64_tr_b16 a[36:37], v249 offset:8192
    s_add_u32 m0, s75, 2048
    s_add_u32 s68, s71, 229376
    buffer_load_dwordx4 v252, s[28:31], s68 offen lds
    ds_read_b64_tr_b16 a[38:39], v249 offset:9216
    ds_read_b64_tr_b16 a[40:41], v248 offset:10240
    ds_read_b64_tr_b16 a[42:43], v248 offset:11264
    buffer_load_dwordx4 v253, s[28:31], s68 offen offset:1024 lds
    ds_read_b64_tr_b16 a[44:45], v249 offset:10240
    ds_read_b64_tr_b16 a[46:47], v249 offset:11264
    ds_read_b64_tr_b16 a[48:49], v248 offset:12288
    ds_read_b64_tr_b16 a[50:51], v248 offset:13312
    ds_read_b64_tr_b16 a[52:53], v249 offset:12288
    ds_read_b64_tr_b16 a[54:55], v249 offset:13312
    s_add_u32 m0, s75, 4096
    s_add_u32 s68, s71, 286720
    buffer_load_dwordx4 v252, s[28:31], s68 offen lds
    ds_read_b64_tr_b16 a[56:57], v179 offset:0
    ds_read_b64_tr_b16 a[58:59], v179 offset:1024
    ds_read_b64_tr_b16 a[60:61], v180 offset:0
    buffer_load_dwordx4 v253, s[28:31], s68 offen offset:1024 lds
    ds_read_b64_tr_b16 a[62:63], v180 offset:1024
    s_waitcnt vmcnt(10)
    ds_read_b64_tr_b16 a[64:65], v179 offset:2048
    ds_read_b64_tr_b16 a[66:67], v179 offset:3072
    ds_read_b64_tr_b16 a[68:69], v180 offset:2048
    ds_read_b64_tr_b16 a[70:71], v180 offset:3072
    s_waitcnt vmcnt(8)
    ds_read_b64_tr_b16 a[72:73], v179 offset:4096
    s_add_u32 m0, s75, 6144
    s_add_u32 s68, s71, 344064
    buffer_load_dwordx4 v252, s[28:31], s68 offen lds
    ds_read_b64_tr_b16 a[74:75], v179 offset:5120
    ds_read_b64_tr_b16 a[76:77], v180 offset:4096
    ds_read_b64_tr_b16 a[78:79], v180 offset:5120
    buffer_load_dwordx4 v253, s[28:31], s68 offen offset:1024 lds
    s_add_u32 m0, s75, 8192
    s_add_u32 s68, s72, 0
    buffer_load_dwordx4 v252, s[28:31], s68 offen lds
    buffer_load_dwordx4 v253, s[28:31], s68 offen offset:1024 lds
    s_waitcnt vmcnt(10)
    s_waitcnt lgkmcnt(0)
    s_barrier
    v_mov_b32 v10, s57
    v_cmp_eq_u32 vcc, 0, v0
    v_bfrev_b32 v11, 1
    s_nop 0
    v_cndmask_b32 v11, v11, 0, vcc
    buffer_store_dword v10, v11, s[48:51], s77 offen sc1
    buffer_load_ushort v204, v205, s[32:35], 0 offen
    buffer_load_ushort v205, v205, s[32:35], 0 offen offset:64
    s_branch GEMMS
STATS:
    s_lshl_b32 s58, s53, 6
    s_lshl_b32 s59, s54, 4
    s_add_u32 s60, s58, s59
    s_mul_i32 s58, s60, 896
    v_mul_u32_u24 v7, 896, v255
    v_lshl_add_u32 v7, v6, 4, v7
    v_add_u32 v7, s58, v7
    v_add_u32 v8, 7168, v7
    s_waitcnt lgkmcnt(0)
    buffer_store_byte v236, v237, s[44:47], 0 offen
    buffer_load_dwordx4 v[20:23], v7, s[4:7], 0 offen offset:0
    buffer_load_dwordx4 v[24:27], v7, s[4:7], 0 offen offset:128
    buffer_load_dwordx4 v[28:31], v7, s[4:7], 0 offen offset:256
    buffer_load_dwordx4 v[32:35], v7, s[4:7], 0 offen offset:384
    buffer_load_dwordx4 v[36:39], v7, s[4:7], 0 offen offset:512
    buffer_load_dwordx4 v[40:43], v7, s[4:7], 0 offen offset:640
    buffer_load_dwordx4 v[44:47], v7, s[4:7], 0 offen offset:768
    buffer_load_dwordx4 v[48:51], v8, s[4:7], 0 offen offset:0
    buffer_load_dwordx4 v[52:55], v8, s[4:7], 0 offen offset:128
    buffer_load_dwordx4 v[56:59], v8, s[4:7], 0 offen offset:256
    buffer_load_dwordx4 v[60:63], v8, s[4:7], 0 offen offset:384
    buffer_load_dwordx4 v[64:67], v8, s[4:7], 0 offen offset:512
    buffer_load_dwordx4 v[68:71], v8, s[4:7], 0 offen offset:640
    buffer_load_dwordx4 v[72:75], v8, s[4:7], 0 offen offset:768
    s_mov_b32 s76, s60
    buffer_load_dword v16, off, s[44:47], 0 offset:252 sc1
    s_mul_i32 s58, s52, 28
    s_add_u32 s58, s58, s53
    s_lshl_b32 s58, s58, 2
    s_add_u32 s58, s58, s54
    s_mul_i32 s58, s58, 1792
    v_min_u32 v246, 13, v1
    v_lshl_add_u32 v246, v246, 7, s58
    v_bfe_u32 v10, v1, 2, 2
    v_lshrrev_b32_e64 v11, 5, v1
    v_lshl_add_u32 v11, v11, 2, v10
    v_lshlrev_b32_e64 v250, 7, v11
    v_bfe_u32 v11, v1, 4, 1
    v_lshl_or_b32 v250, v11, 5, v250
    v_and_b32_e64 v11, 3, v1
    v_lshl_or_b32 v250, v11, 3, v250
    v_bfe_u32 v11, v1, 3, 1
    v_lshl_or_b32 v250, v11, 6, v250
    v_bfe_u32 v10, v1, 2, 1
    v_bfe_u32 v11, v1, 4, 1
    v_mov_b32 v12, 0x3f803f80
    v_cmp_eq_u32 vcc, v10, v11
    s_nop 1
    v_cndmask_b32 v200, 0, v12, vcc
    v_cndmask_b32 v201, 0, v12, vcc
    v_cndmask_b32 v202, 0, v12, vcc
    v_cndmask_b32 v203, 0, v12, vcc
    v_bfe_u32 v10, v255, 1, 1
    v_lshlrev_b32 v10, 2, v10
    v_xor_b32 v10, v10, v6
    v_lshlrev_b32 v254, 4, v10
    s_lshl_b32 s58, s56, 9
    s_lshl_b32 s59, s54, 7
    s_add_u32 s58, s58, s59
    v_mul_u32_u24 v11, 3584, v255
    v_add3_u32 v252, v254, v11, s58
    v_add_u32 v253, 27648, v252
    v_and_b32 v10, 31, v1
    v_lshlrev_b32 v10, 1, v10
    v_add_u32 v205, s58, v10
    buffer_load_ushort v204, v205, s[32:35], 0 offen
    buffer_load_ushort v205, v205, s[32:35], 0 offen offset:64
    s_lshl_b32 s69, s55, 3
    s_lshr_b32 s69, 3839418852, s69
    s_lshr_b32 s70, s69, 0
    s_add_u32 s70, s70, s54
    s_and_b32 s70, s70, 3
    s_mul_i32 s70, s70, 401408
    s_lshr_b32 s71, s69, 2
    s_add_u32 s71, s71, s54
    s_and_b32 s71, s71, 3
    s_mul_i32 s71, s71, 401408
    s_lshr_b32 s72, s69, 4
    s_add_u32 s72, s72, s54
    s_and_b32 s72, s72, 3
    s_mul_i32 s72, s72, 401408
    s_lshr_b32 s73, s69, 6
    s_add_u32 s73, s73, s54
    s_and_b32 s73, s73, 3
    s_mul_i32 s73, s73, 401408
    v_mov_b32 v9, 0x3f803f80
    s_waitcnt vmcnt(16)
    v_dot2_f32_bf16 v10, v20, v9, 0
    v_dot2_f32_bf16 v11, v20, v20, 0
    v_dot2_f32_bf16 v10, v21, v9, v10
    v_dot2_f32_bf16 v11, v21, v21, v11
    v_dot2_f32_bf16 v10, v22, v9, v10
    v_dot2_f32_bf16 v11, v22, v22, v11
    v_dot2_f32_bf16 v10, v23, v9, v10
    v_dot2_f32_bf16 v11, v23, v23, v11
    s_waitcnt vmcnt(15)
    v_dot2_f32_bf16 v10, v24, v9, v10
    v_dot2_f32_bf16 v11, v24, v24, v11
    v_dot2_f32_bf16 v10, v25, v9, v10
    v_dot2_f32_bf16 v11, v25, v25, v11
    v_dot2_f32_bf16 v10, v26, v9, v10
    v_dot2_f32_bf16 v11, v26, v26, v11
    v_dot2_f32_bf16 v10, v27, v9, v10
    v_dot2_f32_bf16 v11, v27, v27, v11
    s_waitcnt vmcnt(14)
    v_dot2_f32_bf16 v10, v28, v9, v10
    v_dot2_f32_bf16 v11, v28, v28, v11
    v_dot2_f32_bf16 v10, v29, v9, v10
    v_dot2_f32_bf16 v11, v29, v29, v11
    v_dot2_f32_bf16 v10, v30, v9, v10
    v_dot2_f32_bf16 v11, v30, v30, v11
    v_dot2_f32_bf16 v10, v31, v9, v10
    v_dot2_f32_bf16 v11, v31, v31, v11
    s_waitcnt vmcnt(13)
    v_dot2_f32_bf16 v10, v32, v9, v10
    v_dot2_f32_bf16 v11, v32, v32, v11
    v_dot2_f32_bf16 v10, v33, v9, v10
    v_dot2_f32_bf16 v11, v33, v33, v11
    v_dot2_f32_bf16 v10, v34, v9, v10
    v_dot2_f32_bf16 v11, v34, v34, v11
    v_dot2_f32_bf16 v10, v35, v9, v10
    v_dot2_f32_bf16 v11, v35, v35, v11
    s_waitcnt vmcnt(12)
    v_dot2_f32_bf16 v10, v36, v9, v10
    v_dot2_f32_bf16 v11, v36, v36, v11
    v_dot2_f32_bf16 v10, v37, v9, v10
    v_dot2_f32_bf16 v11, v37, v37, v11
    v_dot2_f32_bf16 v10, v38, v9, v10
    v_dot2_f32_bf16 v11, v38, v38, v11
    v_dot2_f32_bf16 v10, v39, v9, v10
    v_dot2_f32_bf16 v11, v39, v39, v11
    s_waitcnt vmcnt(11)
    v_dot2_f32_bf16 v10, v40, v9, v10
    v_dot2_f32_bf16 v11, v40, v40, v11
    v_dot2_f32_bf16 v10, v41, v9, v10
    v_dot2_f32_bf16 v11, v41, v41, v11
    v_dot2_f32_bf16 v10, v42, v9, v10
    v_dot2_f32_bf16 v11, v42, v42, v11
    v_dot2_f32_bf16 v10, v43, v9, v10
    v_dot2_f32_bf16 v11, v43, v43, v11
    s_waitcnt vmcnt(10)
    v_dot2_f32_bf16 v10, v44, v9, v10
    v_dot2_f32_bf16 v11, v44, v44, v11
    v_dot2_f32_bf16 v10, v45, v9, v10
    v_dot2_f32_bf16 v11, v45, v45, v11
    v_dot2_f32_bf16 v10, v46, v9, v10
    v_dot2_f32_bf16 v11, v46, v46, v11
    v_dot2_f32_bf16 v10, v47, v9, v10
    v_dot2_f32_bf16 v11, v47, v47, v11
    s_waitcnt vmcnt(9)
    v_dot2_f32_bf16 v12, v48, v9, 0
    v_dot2_f32_bf16 v13, v48, v48, 0
    v_dot2_f32_bf16 v12, v49, v9, v12
    v_dot2_f32_bf16 v13, v49, v49, v13
    v_dot2_f32_bf16 v12, v50, v9, v12
    v_dot2_f32_bf16 v13, v50, v50, v13
    v_dot2_f32_bf16 v12, v51, v9, v12
    v_dot2_f32_bf16 v13, v51, v51, v13
    s_waitcnt vmcnt(8)
    v_dot2_f32_bf16 v12, v52, v9, v12
    v_dot2_f32_bf16 v13, v52, v52, v13
    v_dot2_f32_bf16 v12, v53, v9, v12
    v_dot2_f32_bf16 v13, v53, v53, v13
    v_dot2_f32_bf16 v12, v54, v9, v12
    v_dot2_f32_bf16 v13, v54, v54, v13
    v_dot2_f32_bf16 v12, v55, v9, v12
    v_dot2_f32_bf16 v13, v55, v55, v13
    s_waitcnt vmcnt(7)
    v_dot2_f32_bf16 v12, v56, v9, v12
    v_dot2_f32_bf16 v13, v56, v56, v13
    v_dot2_f32_bf16 v12, v57, v9, v12
    v_dot2_f32_bf16 v13, v57, v57, v13
    v_dot2_f32_bf16 v12, v58, v9, v12
    v_dot2_f32_bf16 v13, v58, v58, v13
    v_dot2_f32_bf16 v12, v59, v9, v12
    v_dot2_f32_bf16 v13, v59, v59, v13
    s_waitcnt vmcnt(6)
    v_dot2_f32_bf16 v12, v60, v9, v12
    v_dot2_f32_bf16 v13, v60, v60, v13
    v_dot2_f32_bf16 v12, v61, v9, v12
    v_dot2_f32_bf16 v13, v61, v61, v13
    v_dot2_f32_bf16 v12, v62, v9, v12
    v_dot2_f32_bf16 v13, v62, v62, v13
    v_dot2_f32_bf16 v12, v63, v9, v12
    v_dot2_f32_bf16 v13, v63, v63, v13
    s_waitcnt vmcnt(5)
    v_dot2_f32_bf16 v12, v64, v9, v12
    v_dot2_f32_bf16 v13, v64, v64, v13
    v_dot2_f32_bf16 v12, v65, v9, v12
    v_dot2_f32_bf16 v13, v65, v65, v13
    v_dot2_f32_bf16 v12, v66, v9, v12
    v_dot2_f32_bf16 v13, v66, v66, v13
    v_dot2_f32_bf16 v12, v67, v9, v12
    v_dot2_f32_bf16 v13, v67, v67, v13
    s_waitcnt vmcnt(4)
    v_dot2_f32_bf16 v12, v68, v9, v12
    v_dot2_f32_bf16 v13, v68, v68, v13
    v_dot2_f32_bf16 v12, v69, v9, v12
    v_dot2_f32_bf16 v13, v69, v69, v13
    v_dot2_f32_bf16 v12, v70, v9, v12
    v_dot2_f32_bf16 v13, v70, v70, v13
    v_dot2_f32_bf16 v12, v71, v9, v12
    v_dot2_f32_bf16 v13, v71, v71, v13
    s_waitcnt vmcnt(3)
    v_dot2_f32_bf16 v12, v72, v9, v12
    v_dot2_f32_bf16 v13, v72, v72, v13
    v_dot2_f32_bf16 v12, v73, v9, v12
    v_dot2_f32_bf16 v13, v73, v73, v13
    v_dot2_f32_bf16 v12, v74, v9, v12
    v_dot2_f32_bf16 v13, v74, v74, v13
    v_dot2_f32_bf16 v12, v75, v9, v12
    v_dot2_f32_bf16 v13, v75, v75, v13
    v_add_f32_dpp v10, v10, v10 quad_perm:[1,0,3,2] row_mask:0xf bank_mask:0xf
    v_add_f32_dpp v11, v11, v11 quad_perm:[1,0,3,2] row_mask:0xf bank_mask:0xf
    v_add_f32_dpp v12, v12, v12 quad_perm:[1,0,3,2] row_mask:0xf bank_mask:0xf
    v_add_f32_dpp v13, v13, v13 quad_perm:[1,0,3,2] row_mask:0xf bank_mask:0xf
    v_add_f32_dpp v10, v10, v10 quad_perm:[2,3,0,1] row_mask:0xf bank_mask:0xf
    v_add_f32_dpp v11, v11, v11 quad_perm:[2,3,0,1] row_mask:0xf bank_mask:0xf
    v_add_f32_dpp v12, v12, v12 quad_perm:[2,3,0,1] row_mask:0xf bank_mask:0xf
    v_add_f32_dpp v13, v13, v13 quad_perm:[2,3,0,1] row_mask:0xf bank_mask:0xf
    v_add_f32_dpp v10, v10, v10 row_half_mirror row_mask:0xf bank_mask:0xf
    v_add_f32_dpp v11, v11, v11 row_half_mirror row_mask:0xf bank_mask:0xf
    v_add_f32_dpp v12, v12, v12 row_half_mirror row_mask:0xf bank_mask:0xf
    v_add_f32_dpp v13, v13, v13 row_half_mirror row_mask:0xf bank_mask:0xf
    v_and_b32 v14, 1, v6
    v_cmp_eq_u32 vcc, 1, v14
    s_nop 1
    v_cndmask_b32 v10, v10, v12, vcc
    v_cndmask_b32_e64 v11, v11, v13, vcc
    v_mul_f32 v10, 0x3b124925, v10
    v_mul_f32 v11, 0x3b124925, v11
    v_fma_f32 v11, -v10, v10, v11
    v_max_f32_e64 v11, 0, v11
    v_add_f32 v11, 0x3727c5ac, v11
    v_rsq_f32 v11, v11
    v_and_b32 v12, 2, v6
    v_cmp_eq_u32 vcc, 2, v12
    v_mul_f32 v10, -1.0, v10
    v_mul_f32 v10, v10, v11
    v_cndmask_b32 v10, v11, v10, vcc
    v_lshl_add_u32 v13, v14, 3, v255
    v_add_lshl_u32 v13, v13, s76, 2
    v_lshl_add_u32 v13, v12, 12, v13
    v_bfrev_b32 v12, 1
    v_cmp_gt_u32 vcc, 4, v6
    s_mov_b32 s58, 4194304
    s_nop 0
    v_cndmask_b32 v13, v12, v13, vcc
    buffer_store_dword v10, v13, s[48:51], s58 offen sc1
    s_waitcnt vmcnt(3)
    v_readfirstlane_b32 s57, v16
    s_cmp_lg_u32 s57, 0
    s_cbranch_scc1 npolld_18
    s_mov_b32 s69, 1000000
npoll_17:
    buffer_load_dword v16, off, s[44:47], 0 offset:252 sc1
    s_waitcnt vmcnt(0)
    v_readfirstlane_b32 s57, v16
    s_cmp_lg_u32 s57, 0
    s_cbranch_scc1 npolld_18
    s_sub_u32 s69, s69, 1
    s_cbranch_scc0 npoll_17
npolld_18:
    s_lshl_b32 s58, s53, 3
    s_add_u32 s58, s58, 16784384
    s_waitcnt vmcnt(0)
    s_barrier
    v_mov_b32 v10, s57
    v_cmp_eq_u32_e64 vcc, 0, v0
    v_bfrev_b32 v11, 1
    s_nop 0
    v_cndmask_b32 v11, v11, 0, vcc
    buffer_store_dword v10, v11, s[48:51], s58 offen sc1
    buffer_load_dword v244, v246, s[28:31], 0 offen
    s_mul_i32 s74, s54, 40960
    v_add_u32 v248, s74, v250
    v_xor_b32 v249, 64, v248
    s_add_u32 m0, s74, 0
    s_add_u32 s68, s70, 0
    buffer_load_dwordx4 v252, s[28:31], s68 offen lds
    buffer_load_dwordx4 v253, s[28:31], s68 offen offset:1024 lds
    s_add_u32 m0, s74, 2048
    s_add_u32 s68, s70, 57344
    buffer_load_dwordx4 v252, s[28:31], s68 offen lds
    buffer_load_dwordx4 v253, s[28:31], s68 offen offset:1024 lds
    s_add_u32 m0, s74, 4096
    s_add_u32 s68, s70, 114688
    buffer_load_dwordx4 v252, s[28:31], s68 offen lds
    buffer_load_dwordx4 v253, s[28:31], s68 offen offset:1024 lds
    s_add_u32 m0, s74, 6144
    s_add_u32 s68, s70, 172032
    buffer_load_dwordx4 v252, s[28:31], s68 offen lds
    buffer_load_dwordx4 v253, s[28:31], s68 offen offset:1024 lds
    s_add_u32 m0, s74, 8192
    s_add_u32 s68, s70, 229376
    buffer_load_dwordx4 v252, s[28:31], s68 offen lds
    buffer_load_dwordx4 v253, s[28:31], s68 offen offset:1024 lds
    s_add_u32 m0, s74, 10240
    s_add_u32 s68, s70, 286720
    buffer_load_dwordx4 v252, s[28:31], s68 offen lds
    buffer_load_dwordx4 v253, s[28:31], s68 offen offset:1024 lds
    s_add_u32 m0, s74, 12288
    s_add_u32 s68, s70, 344064
    buffer_load_dwordx4 v252, s[28:31], s68 offen lds
    buffer_load_dwordx4 v253, s[28:31], s68 offen offset:1024 lds
    s_add_u32 m0, s74, 14336
    s_add_u32 s68, s71, 0
    buffer_load_dwordx4 v252, s[28:31], s68 offen lds
    buffer_load_dwordx4 v253, s[28:31], s68 offen offset:1024 lds
    s_add_u32 m0, s74, 16384
    s_add_u32 s68, s71, 57344
    buffer_load_dwordx4 v252, s[28:31], s68 offen lds
    buffer_load_dwordx4 v253, s[28:31], s68 offen offset:1024 lds
    s_add_u32 m0, s74, 18432
    s_add_u32 s68, s71, 114688
    buffer_load_dwordx4 v252, s[28:31], s68 offen lds
    buffer_load_dwordx4 v253, s[28:31], s68 offen offset:1024 lds
    buffer_load_dword v238, v239, s[44:47], 0 offen sc1
    buffer_load_dword v242, v246, s[36:39], 0 offen
    s_waitcnt vmcnt(20)
    ds_read_b64_tr_b16 a[0:1], v248 offset:0
    ds_read_b64_tr_b16 a[2:3], v248 offset:1024
    ds_read_b64_tr_b16 a[4:5], v249 offset:0
    ds_read_b64_tr_b16 a[6:7], v249 offset:1024
    s_waitcnt vmcnt(18)
    ds_read_b64_tr_b16 a[8:9], v248 offset:2048
    ds_read_b64_tr_b16 a[10:11], v248 offset:3072
    ds_read_b64_tr_b16 a[12:13], v249 offset:2048
    ds_read_b64_tr_b16 a[14:15], v249 offset:3072
    s_waitcnt vmcnt(16)
    ds_read_b64_tr_b16 a[16:17], v248 offset:4096
    ds_read_b64_tr_b16 a[18:19], v248 offset:5120
    ds_read_b64_tr_b16 a[20:21], v249 offset:4096
    ds_read_b64_tr_b16 a[22:23], v249 offset:5120
    s_waitcnt vmcnt(14)
    ds_read_b64_tr_b16 a[24:25], v248 offset:6144
    ds_read_b64_tr_b16 a[26:27], v248 offset:7168
    ds_read_b64_tr_b16 a[28:29], v249 offset:6144
    ds_read_b64_tr_b16 a[30:31], v249 offset:7168
    s_waitcnt vmcnt(12)
    ds_read_b64_tr_b16 a[32:33], v248 offset:8192
    ds_read_b64_tr_b16 a[34:35], v248 offset:9216
    ds_read_b64_tr_b16 a[36:37], v249 offset:8192
    ds_read_b64_tr_b16 a[38:39], v249 offset:9216
    s_waitcnt vmcnt(10)
    ds_read_b64_tr_b16 a[40:41], v248 offset:10240
    ds_read_b64_tr_b16 a[42:43], v248 offset:11264
    ds_read_b64_tr_b16 a[44:45], v249 offset:10240
    ds_read_b64_tr_b16 a[46:47], v249 offset:11264
    s_waitcnt vmcnt(8)
    ds_read_b64_tr_b16 a[48:49], v248 offset:12288
    ds_read_b64_tr_b16 a[50:51], v248 offset:13312
    ds_read_b64_tr_b16 a[52:53], v249 offset:12288
    ds_read_b64_tr_b16 a[54:55], v249 offset:13312
    s_waitcnt vmcnt(6)
    ds_read_b64_tr_b16 a[56:57], v248 offset:14336
    ds_read_b64_tr_b16 a[58:59], v248 offset:15360
    ds_read_b64_tr_b16 a[60:61], v249 offset:14336
    ds_read_b64_tr_b16 a[62:63], v249 offset:15360
    s_waitcnt vmcnt(4)
    ds_read_b64_tr_b16 a[64:65], v248 offset:16384
    ds_read_b64_tr_b16 a[66:67], v248 offset:17408
    ds_read_b64_tr_b16 a[68:69], v249 offset:16384
    ds_read_b64_tr_b16 a[70:71], v249 offset:17408
    s_waitcnt vmcnt(2)
    ds_read_b64_tr_b16 a[72:73], v248 offset:18432
    ds_read_b64_tr_b16 a[74:75], v248 offset:19456
    ds_read_b64_tr_b16 a[76:77], v249 offset:18432
    ds_read_b64_tr_b16 a[78:79], v249 offset:19456
    s_waitcnt vmcnt(1)
    v_cmp_ne_u32_e64 vcc, s26, v238
    s_cmp_eq_u64 vcc, 0
    s_cselect_b32 s27, 1, 0
    s_waitcnt vmcnt(0) lgkmcnt(0)
    s_barrier
    s_mul_i32 s74, s54, 14336
    s_add_u32 s74, s74, 101376
    v_add_u32 v248, s74, v250
    v_xor_b32 v249, 64, v248
    s_mul_i32 s75, s54, 10240
    s_add_u32 s75, s75, 57344
    v_add_u32_e64 v238, s75, v250
    v_xor_b32 v239, 64, v238
    s_add_u32 m0, s75, 0
    s_add_u32 s68, s71, 172032
    buffer_load_dwordx4 v252, s[28:31], s68 offen lds
    buffer_load_dwordx4 v253, s[28:31], s68 offen offset:1024 lds
    s_add_u32 m0, s75, 2048
    s_add_u32 s68, s71, 229376
    buffer_load_dwordx4 v252, s[28:31], s68 offen lds
    buffer_load_dwordx4 v253, s[28:31], s68 offen offset:1024 lds
    s_add_u32 m0, s75, 4096
    s_add_u32 s68, s71, 286720
    buffer_load_dwordx4 v252, s[28:31], s68 offen lds
    buffer_load_dwordx4 v253, s[28:31], s68 offen offset:1024 lds
    s_add_u32 m0, s75, 6144
    s_add_u32 s68, s71, 344064
    buffer_load_dwordx4 v252, s[28:31], s68 offen lds
    buffer_load_dwordx4 v253, s[28:31], s68 offen offset:1024 lds
    s_add_u32 m0, s75, 8192
    s_add_u32 s68, s72, 0
    buffer_load_dwordx4 v252, s[28:31], s68 offen lds
    buffer_load_dwordx4 v253, s[28:31], s68 offen offset:1024 lds
    s_waitcnt vmcnt(0)
    s_nop 4
GEMMS:
    s_cmp_ge_u32 s53, 28
    s_cbranch_scc1 HELP
    v_mfma_f32_16x16x32_bf16 v[240:243], v[200:203], a[0:3], 0
    s_add_u32 m0, s74, 0
    s_add_u32 s68, s72, 57344
    buffer_load_dwordx4 v252, s[28:31], s68 offen lds
    v_mfma_f32_16x16x32_bf16 v[244:247], v[200:203], a[4:7], 0
    s_lshl_b32 s69, s55, 3
    buffer_load_dwordx4 v253, s[28:31], s68 offen offset:1024 lds
    s_lshr_b32 s69, 3839418852, s69
    s_lshr_b32 s60, s69, 0
    v_mfma_f32_16x16x32_bf16 v[240:243], v[200:203], a[8:11], v[240:243]
    s_add_u32 m0, s74, 2048
    s_add_u32 s68, s72, 114688
    buffer_load_dwordx4 v252, s[28:31], s68 offen lds
    s_add_u32 s60, s60, s54
    v_mfma_f32_16x16x32_bf16 v[244:247], v[200:203], a[12:15], v[244:247]
    s_and_b32 s60, s60, 3
    buffer_load_dwordx4 v253, s[28:31], s68 offen offset:1024 lds
    s_mul_i32 s60, s60, 14336
    s_lshr_b32 s61, s69, 2
    v_mfma_f32_16x16x32_bf16 v[240:243], v[200:203], a[16:19], v[240:243]
    s_add_u32 m0, s74, 4096
    s_add_u32 s68, s72, 172032
    buffer_load_dwordx4 v252, s[28:31], s68 offen lds
    s_add_u32 s61, s61, s54
    v_mfma_f32_16x16x32_bf16 v[244:247], v[200:203], a[20:23], v[244:247]
    s_and_b32 s61, s61, 3
    buffer_load_dwordx4 v253, s[28:31], s68 offen offset:1024 lds
    s_mul_i32 s61, s61, 14336
    s_lshr_b32 s62, s69, 4
    v_mfma_f32_16x16x32_bf16 v[240:243], v[200:203], a[24:27], v[240:243]
    s_add_u32 m0, s74, 6144
    s_add_u32 s68, s72, 229376
    buffer_load_dwordx4 v252, s[28:31], s68 offen lds
    s_add_u32 s62, s62, s54
    v_mfma_f32_16x16x32_bf16 v[244:247], v[200:203], a[28:31], v[244:247]
    s_and_b32 s62, s62, 3
    buffer_load_dwordx4 v253, s[28:31], s68 offen offset:1024 lds
    s_mul_i32 s62, s62, 14336
    s_lshr_b32 s63, s69, 6
    v_mfma_f32_16x16x32_bf16 v[240:243], v[200:203], a[32:35], v[240:243]
    s_add_u32 m0, s74, 8192
    s_add_u32 s68, s72, 286720
    buffer_load_dwordx4 v252, s[28:31], s68 offen lds
    s_add_u32 s63, s63, s54
    v_mfma_f32_16x16x32_bf16 v[244:247], v[200:203], a[36:39], v[244:247]
    s_and_b32 s63, s63, 3
    s_mul_i32 s63, s63, 14336
    s_lshl_b32 s58, s60, 5
    s_lshl_b32 s59, s55, 7
    s_add_u32 s58, s58, s59
    v_mfma_f32_16x16x32_bf16 v[240:243], v[200:203], a[40:43], v[240:243]
    s_add_u32 s58, s58, 5242880
    v_lshl_add_u32 v14, v255, 12, v254
    v_add_u32 v14, s58, v14
    v_and_b32 v15, 3, v255
    v_lshlrev_b32 v15, 7, v15
    v_mfma_f32_16x16x32_bf16 v[244:247], v[200:203], a[44:47], v[244:247]
    s_mov_b32 s67, s60
    buffer_load_dwordx4 v253, s[28:31], s68 offen offset:1024 lds
    v_xor_b32_e64 v14, v14, v15
    v_add_u32 v15, 31744, v14
    v_mfma_f32_16x16x32_bf16 v[240:243], v[200:203], a[48:51], v[240:243]
    v_add_u32 v104, s60, v250
    v_xor_b32 v105, 64, v104
    v_add_u32 v106, s61, v250
    v_xor_b32 v107, 64, v106
    v_mfma_f32_16x16x32_bf16 v[244:247], v[200:203], a[52:55], v[244:247]
    v_add_u32 v108, s62, v250
    v_xor_b32 v109, 64, v108
    v_add_u32_e64 v110, s63, v250
    v_xor_b32 v111, 64, v110
    v_mfma_f32_16x16x32_bf16 v[240:243], v[200:203], a[56:59], v[240:243]
    s_lshr_b32 s76, s67, 3
    s_add_u32 s76, s76, 17039360
    s_mov_b32 s61, 90452256
    v_min_u32 v12, 55, v1
    v_lshlrev_b32 v12, 5, v12
    v_mfma_f32_16x16x32_bf16 v[244:247], v[200:203], a[60:63], v[244:247]
    s_add_u32 m0, s74, 10240
    s_add_u32 s68, s72, 344064
    buffer_load_dwordx4 v252, s[28:31], s68 offen lds
    s_mov_b32 s62, 106119696
    v_mfma_f32_16x16x32_bf16 v[240:243], v[200:203], a[64:67], v[240:243]
    s_bitcmp1_b32 s55, 0
    s_cselect_b32 s60, 106177296, s61
    s_cselect_b32 s61, 105198096, s62
    s_bitcmp1_b32 s55, 1
    s_cselect_b32 s60, s61, s60
    v_mfma_f32_16x16x32_bf16 v[244:247], v[200:203], a[68:71], v[244:247]
    s_waitcnt vmcnt(22)
    ds_read_b64_tr_b16 a[80:81], v238 offset:0
    ds_read_b64_tr_b16 a[82:83], v238 offset:1024
    ds_read_b64_tr_b16 a[84:85], v239 offset:0
    ds_read_b64_tr_b16 a[86:87], v239 offset:1024
    v_mfma_f32_16x16x32_bf16 v[240:243], v[200:203], a[72:75], v[240:243]
    s_waitcnt vmcnt(20)
    ds_read_b64_tr_b16 a[88:89], v238 offset:2048
    ds_read_b64_tr_b16 a[90:91], v238 offset:3072
    ds_read_b64_tr_b16 a[92:93], v239 offset:2048
    ds_read_b64_tr_b16 a[94:95], v239 offset:3072
    v_mfma_f32_16x16x32_bf16 v[244:247], v[200:203], a[76:79], v[244:247]
    s_waitcnt vmcnt(18)
    buffer_load_dwordx4 v253, s[28:31], s68 offen offset:1024 lds
    ds_read_b64_tr_b16 a[96:97], v238 offset:4096
    ds_read_b64_tr_b16 a[98:99], v238 offset:5120
    ds_read_b64_tr_b16 a[100:101], v239 offset:4096
    ds_read_b64_tr_b16 a[102:103], v239 offset:5120
    s_waitcnt vmcnt(17)
    ds_read_b64_tr_b16 a[104:105], v238 offset:6144
    ds_read_b64_tr_b16 a[106:107], v238 offset:7168
    ds_read_b64_tr_b16 a[108:109], v239 offset:6144
    ds_read_b64_tr_b16 a[110:111], v239 offset:7168
    s_waitcnt vmcnt(15)
    ds_read_b64_tr_b16 a[112:113], v238 offset:8192
    ds_read_b64_tr_b16 a[114:115], v238 offset:9216
    ds_read_b64_tr_b16 a[116:117], v239 offset:8192
    s_branch SKIP3
PAD3:
    s_branch HOPBACK
SKIP3:
    ds_read_b64_tr_b16 a[118:119], v239 offset:9216
    s_add_u32 s58, s56, 0
    s_cmp_ge_u32 s58, 7
    s_cselect_b32 s59, 7, 0
    s_waitcnt lgkmcnt(15)
    v_mfma_f32_16x16x32_bf16 v[240:243], v[200:203], a[80:83], v[240:243]
    s_sub_u32 s58, s58, s59
    s_mul_i32 s8, s58, 229376
    s_lshl_b32 s16, s58, 14
    s_bfe_u32 s58, s60, 196612
    s_add_u32 s58, s56, s58
    v_mfma_f32_16x16x32_bf16 v[244:247], v[200:203], a[84:87], v[244:247]
    s_add_u32 m0, s74, 12288
    s_add_u32 s68, s73, 0
    buffer_load_dwordx4 v252, s[28:31], s68 offen lds
    s_waitcnt lgkmcnt(14)
    v_mfma_f32_16x16x32_bf16 v[240:243], v[200:203], a[88:91], v[240:243]
    s_cmp_ge_u32 s58, 7
    s_cselect_b32 s59, 7, 0
    s_sub_u32 s58, s58, s59
    s_mul_i32 s9, s58, 229376
    s_lshl_b32 s17, s58, 14
    s_waitcnt lgkmcnt(12)
    v_mfma_f32_16x16x32_bf16 v[244:247], v[200:203], a[92:95], v[244:247]
    s_bfe_u32 s58, s60, 196616
    s_add_u32 s58, s56, s58
    s_cmp_ge_u32 s58, 7
    s_cselect_b32 s59, 7, 0
    s_sub_u32 s58, s58, s59
    s_waitcnt lgkmcnt(10)
    v_mfma_f32_16x16x32_bf16 v[240:243], v[200:203], a[96:99], v[240:243]
    s_mul_i32 s10, s58, 229376
    s_lshl_b32 s18, s58, 14
    s_bfe_u32 s58, s60, 196620
    s_add_u32 s58, s56, s58
    s_waitcnt lgkmcnt(8)
    v_mfma_f32_16x16x32_bf16 v[244:247], v[200:203], a[100:103], v[244:247]
    s_cmp_ge_u32 s58, 7
    buffer_load_dwordx4 v253, s[28:31], s68 offen offset:1024 lds
    s_cselect_b32 s59, 7, 0
    s_sub_u32 s58, s58, s59
    s_waitcnt lgkmcnt(6)
    v_mfma_f32_16x16x32_bf16 v[240:243], v[200:203], a[104:107], v[240:243]
    s_mul_i32 s11, s58, 229376
    s_lshl_b32 s19, s58, 14
    s_bfe_u32 s58, s60, 196624
    s_add_u32 s58, s56, s58
    s_waitcnt lgkmcnt(4)
    v_mfma_f32_16x16x32_bf16 v[244:247], v[200:203], a[108:111], v[244:247]
    s_cmp_ge_u32 s58, 7
    s_cselect_b32 s59, 7, 0
    s_sub_u32 s58, s58, s59
    s_mul_i32 s12, s58, 229376
    s_lshl_b32 s20, s58, 14
    s_waitcnt lgkmcnt(2)
    v_mfma_f32_16x16x32_bf16 v[240:243], v[200:203], a[112:115], v[240:243]
    s_bfe_u32 s58, s60, 196628
    s_add_u32 s58, s56, s58
    s_cmp_ge_u32 s58, 7
    s_cselect_b32 s59, 7, 0
    s_sub_u32 s58, s58, s59
    s_waitcnt lgkmcnt(0)
    v_mfma_f32_16x16x32_bf16 v[244:247], v[200:203], a[116:119], v[244:247]
    s_add_u32 m0, s75, 0
    s_add_u32 s68, s73, 57344
    buffer_load_dwordx4 v252, s[28:31], s68 offen lds
    s_mul_i32 s13, s58, 229376
    s_lshl_b32 s21, s58, 14
    s_bfe_u32 s58, s60, 196632
    s_add_u32 s58, s56, s58
    s_cmp_ge_u32 s58, 7
    s_cselect_b32 s59, 7, 0
    s_sub_u32 s58, s58, s59
    s_mul_i32 s14, s58, 229376
    s_lshl_b32 s22, s58, 14
    s_mul_i32 s58, s54, 57344
    s_lshl_b32 s59, s56, 7
    s_add_u32 s58, s58, s59
    v_mul_u32_u24 v10, 896, v255
    s_lshl_b32 s3, s54, 5
    v_xor_b32 v11, s3, v254
    v_add3_u32 v114, v11, v10, s58
    buffer_load_dwordx4 v253, s[28:31], s68 offen offset:1024 lds
    v_add_u32 v115, 6144, v114
    v_xor_b32 v254, 32, v114
    v_xor_b32 v255, 32, v115
    v_bfe_u32 v10, v1, 4, 1
    v_mul_u32_u24 v11, 2048, v10
    s_sub_u32 s3, s74, s75
    s_add_u32 s3, s3, 4294957056
    v_add_u32 v132, v11, v238
    v_add_u32 v133, v11, v239
    v_add_u32 v134, v11, v248
    v_add_u32_e64 v135, v11, v249
    v_mad_i32_i24 v136, v10, s3, v132
    v_mad_i32_i24 v137, v10, s3, v133
    v_and_b32 v11, 15, v1
    v_lshlrev_b32 v11, 4, v11
    v_lshl_add_u32 v11, v10, 10, v11
    v_lshrrev_b32_e64 v10, 5, v1
    v_lshl_add_u32 v138, v10, 9, v11
    v_bfe_u32 v10, v1, 3, 1
    v_cmp_eq_u32_e64 vcc, 0, v10
    s_add_u32 m0, s75, 2048
    s_add_u32 s68, s73, 114688
    buffer_load_dwordx4 v252, s[28:31], s68 offen lds
    v_cndmask_b32 v152, 0, v200, vcc
    v_cndmask_b32 v153, 0, v200, vcc
    v_cndmask_b32 v154, 0, v200, vcc
    v_cndmask_b32 v155, 0, v200, vcc
    v_sub_u32 v156, v200, v152
    v_sub_u32 v157, v200, v152
    v_sub_u32_e64 v158, v200, v152
    v_sub_u32 v159, v200, v152
    s_and_b32 s61, s55, 2
    s_lshl_b32 s61, s61, 20
    s_lshl_b32 s60, s52, 18
    s_add_u32 s60, s60, s61
    s_and_b32 s61, s55, 1
    s_mul_i32 s61, s61, 28
    s_waitcnt vmcnt(15)
    ds_read_b64_tr_b16 a[120:121], v248 offset:0
    ds_read_b64_tr_b16 a[122:123], v248 offset:1024
    ds_read_b64_tr_b16 a[124:125], v249 offset:0
    ds_read_b64_tr_b16 a[126:127], v249 offset:1024
    buffer_load_dwordx4 v253, s[28:31], s68 offen offset:1024 lds
    s_add_u32 s61, s61, s54
    s_lshl_b32 s61, s61, 12
    s_add_u32 s60, s60, s61
    s_add_u32 s16, s16, s60
    s_add_u32 s17, s17, s60
    s_add_u32 s18, s18, s60
    s_add_u32 s19, s19, s60
    s_add_u32 s20, s20, s60
    s_add_u32 s21, s21, s60
    s_add_u32 s22, s22, s60
    s_xor_b32 s60, s54, 1
    s_mul_i32 s60, s60, 14336
    s_add_u32 s60, s60, 101376
    v_add_u32_e64 v139, s60, v251
    s_xor_b32 s60, s54, 2
    s_mul_i32 s60, s60, 14336
    s_add_u32 s60, s60, 103424
    v_add_u32 v140, s60, v251
    s_xor_b32 s60, s54, 3
    s_mul_i32 s60, s60, 14336
    s_add_u32 s60, s60, 105472
    v_add_u32 v141, s60, v251
    s_lshl_b32 s60, s56, 2
    s_add_u32 m0, s75, 4096
    s_add_u32 s68, s73, 172032
    buffer_load_dwordx4 v252, s[28:31], s68 offen lds
    s_add_u32 s60, s60, s54
    s_lshl_b32 s61, s60, 11
    s_waitcnt lgkmcnt(2)
    v_mfma_f32_16x16x32_bf16 v[240:243], v[200:203], a[120:123], v[240:243]
    v_and_b32 v142, 0x1d8, v250
    v_lshrrev_b32 v10, 4, v1
    v_lshl_add_u32 v142, v10, 9, v142
    v_add_u32 v142, s61, v142
    s_waitcnt lgkmcnt(0)
    v_mfma_f32_16x16x32_bf16 v[244:247], v[200:203], a[124:127], v[244:247]
    v_and_b32 v143, 31, v1
    v_and_b32 v10, 24, v1
    v_add_u32 v143, v143, v10
    v_mul_u32_u24 v143, 896, v143
    s_waitcnt vmcnt(15)
    ds_read_b64_tr_b16 a[128:129], v248 offset:2048
    ds_read_b64_tr_b16 a[130:131], v248 offset:3072
    ds_read_b64_tr_b16 a[132:133], v249 offset:2048
    ds_read_b64_tr_b16 a[134:135], v249 offset:3072
    buffer_load_dwordx4 v253, s[28:31], s68 offen offset:1024 lds
    buffer_load_dword v4, v12, s[48:51], s76 offen sc1
    v_lshrrev_b32 v10, 5, v1
    v_lshl_add_u32 v143, v10, 4, v143
    s_lshr_b32 s61, s55, 2
    s_lshl_b32 s61, s61, 1
    s_and_b32 s62, s55, 1
    s_add_u32 s61, s61, s62
    s_lshl_b32 s61, s61, 5
    s_and_b32 s62, s55, 2
    s_add_u32 s61, s61, s62
    s_mul_i32 s61, s61, 3584
    s_lshl_b32 s60, s60, 5
    s_add_u32 s61, s61, s60
    v_add_u32 v143, s61, v143
    s_mov_b32 s64, 0.5
    s_add_u32 s66, s16, 8388608
    s_waitcnt lgkmcnt(2)
    v_mfma_f32_16x16x32_bf16 v[240:243], v[200:203], a[128:131], v[240:243]
    s_add_u32 m0, s75, 6144
    s_add_u32 s68, s73, 229376
    buffer_load_dwordx4 v252, s[28:31], s68 offen lds
    s_waitcnt lgkmcnt(0)
    v_mfma_f32_16x16x32_bf16 v[244:247], v[200:203], a[132:135], v[244:247]
    s_waitcnt vmcnt(16)
    ds_read_b64_tr_b16 a[136:137], v248 offset:4096
    ds_read_b64_tr_b16 a[138:139], v248 offset:5120
    ds_read_b64_tr_b16 a[140:141], v249 offset:4096
    ds_read_b64_tr_b16 a[142:143], v249 offset:5120
    buffer_load_dwordx4 v253, s[28:31], s68 offen offset:1024 lds
    s_waitcnt lgkmcnt(2)
    v_mfma_f32_16x16x32_bf16 v[240:243], v[200:203], a[136:139], v[240:243]
    s_add_u32 m0, s75, 8192
    s_add_u32 s68, s73, 286720
    buffer_load_dwordx4 v252, s[28:31], s68 offen lds
    s_waitcnt lgkmcnt(0)
    v_mfma_f32_16x16x32_bf16 v[244:247], v[200:203], a[140:143], v[244:247]
    s_waitcnt vmcnt(16)
    ds_read_b64_tr_b16 a[144:145], v248 offset:6144
    ds_read_b64_tr_b16 a[146:147], v248 offset:7168
    ds_read_b64_tr_b16 a[148:149], v249 offset:6144
    ds_read_b64_tr_b16 a[150:151], v249 offset:7168
    buffer_load_dwordx4 v253, s[28:31], s68 offen offset:1024 lds
    s_waitcnt lgkmcnt(2)
    v_mfma_f32_16x16x32_bf16 v[240:243], v[200:203], a[144:147], v[240:243]
    s_add_u32 m0, s74, 0
    s_add_u32 s68, s73, 344064
    buffer_load_dwordx4 v252, s[28:31], s68 offen lds
    s_waitcnt lgkmcnt(0)
    v_mfma_f32_16x16x32_bf16 v[244:247], v[200:203], a[148:151], v[244:247]
    s_waitcnt vmcnt(16)
    ds_read_b64_tr_b16 a[152:153], v248 offset:8192
    ds_read_b64_tr_b16 a[154:155], v248 offset:9216
    ds_read_b64_tr_b16 a[156:157], v249 offset:8192
    ds_read_b64_tr_b16 a[158:159], v249 offset:9216
    buffer_load_dwordx4 v253, s[28:31], s68 offen offset:1024 lds
    s_waitcnt lgkmcnt(2)
    v_mfma_f32_16x16x32_bf16 v[240:243], v[200:203], a[152:155], v[240:243]
    s_waitcnt lgkmcnt(0)
    v_mfma_f32_16x16x32_bf16 v[244:247], v[200:203], a[156:159], v[244:247]
    s_waitcnt vmcnt(15)
    ds_read_b64_tr_b16 a[160:161], v248 offset:10240
    ds_read_b64_tr_b16 a[162:163], v248 offset:11264
    ds_read_b64_tr_b16 a[164:165], v249 offset:10240
    ds_read_b64_tr_b16 a[166:167], v249 offset:11264
    s_waitcnt lgkmcnt(2)
    v_mfma_f32_16x16x32_bf16 v[240:243], v[200:203], a[160:163], v[240:243]
    s_waitcnt lgkmcnt(0)
    v_mfma_f32_16x16x32_bf16 v[244:247], v[200:203], a[164:167], v[244:247]
    s_waitcnt vmcnt(13)
    ds_read_b64_tr_b16 a[168:169], v248 offset:12288
    ds_read_b64_tr_b16 a[170:171], v248 offset:13312
    ds_read_b64_tr_b16 a[172:173], v249 offset:12288
    ds_read_b64_tr_b16 a[174:175], v249 offset:13312
    s_waitcnt lgkmcnt(2)
    v_mfma_f32_16x16x32_bf16 v[240:243], v[200:203], a[168:171], v[240:243]
    s_waitcnt lgkmcnt(0)
    v_mfma_f32_16x16x32_bf16 v[244:247], v[200:203], a[172:175], v[244:247]
    s_waitcnt vmcnt(11)
    ds_read_b64_tr_b16 a[176:177], v238 offset:0
    ds_read_b64_tr_b16 a[178:179], v238 offset:1024
    ds_read_b64_tr_b16 a[180:181], v239 offset:0
    ds_read_b64_tr_b16 a[182:183], v239 offset:1024
    s_waitcnt lgkmcnt(2)
    v_mfma_f32_16x16x32_bf16 v[240:243], v[200:203], a[176:179], v[240:243]
    s_waitcnt lgkmcnt(0)
    v_mfma_f32_16x16x32_bf16 v[244:247], v[200:203], a[180:183], v[244:247]
    s_waitcnt vmcnt(9)
    ds_read_b64_tr_b16 a[184:185], v238 offset:2048
    ds_read_b64_tr_b16 a[186:187], v238 offset:3072
    ds_read_b64_tr_b16 a[188:189], v239 offset:2048
    ds_read_b64_tr_b16 a[190:191], v239 offset:3072
    s_waitcnt lgkmcnt(2)
    v_mfma_f32_16x16x32_bf16 v[240:243], v[200:203], a[184:187], v[240:243]
    s_waitcnt lgkmcnt(0)
    v_mfma_f32_16x16x32_bf16 v[244:247], v[200:203], a[188:191], v[244:247]
    s_waitcnt vmcnt(7)
    ds_read_b64_tr_b16 a[192:193], v238 offset:4096
    ds_read_b64_tr_b16 a[194:195], v238 offset:5120
    ds_read_b64_tr_b16 a[196:197], v239 offset:4096
    ds_read_b64_tr_b16 a[198:199], v239 offset:5120
    s_waitcnt vmcnt(6)
    v_cmp_ne_u32 vcc, s57, v4
    s_cbranch_vccz polld_20
    s_mov_b32 s69, 1000000
poll_19:
    buffer_load_dword v4, v12, s[48:51], s76 offen sc1
    s_waitcnt vmcnt(0)
    v_cmp_ne_u32_e64 vcc, s57, v4
    s_cbranch_vccz polld_20
    s_sub_u32 s69, s69, 1
    s_cbranch_scc0 poll_19
polld_20:
    s_add_u32 m0, s67, 0
    s_mov_b32 s58, 0
    buffer_load_dwordx4 v14, s[48:51], s58 offen sc1 lds
    buffer_load_dwordx4 v15, s[48:51], s58 offen offset:1024 sc1 lds
    s_add_u32 m0, s67, 2048
    s_mov_b32 s58, 65536
    buffer_load_dwordx4 v14, s[48:51], s58 offen sc1 lds
    buffer_load_dwordx4 v15, s[48:51], s58 offen offset:1024 sc1 lds
    s_add_u32 m0, s67, 4096
    s_mov_b32 s58, 131072
    buffer_load_dwordx4 v14, s[48:51], s58 offen sc1 lds
    buffer_load_dwordx4 v15, s[48:51], s58 offen offset:1024 sc1 lds
    s_add_u32 m0, s67, 6144
    s_mov_b32 s58, 196608
    buffer_load_dwordx4 v14, s[48:51], s58 offen sc1 lds
    buffer_load_dwordx4 v15, s[48:51], s58 offen offset:1024 sc1 lds
    s_add_u32 m0, s67, 8192
    s_mov_b32 s58, 262144
    buffer_load_dwordx4 v14, s[48:51], s58 offen sc1 lds
    buffer_load_dwordx4 v15, s[48:51], s58 offen offset:1024 sc1 lds
    s_add_u32 m0, s67, 10240
    s_mov_b32 s58, 327680
    buffer_load_dwordx4 v14, s[48:51], s58 offen sc1 lds
    buffer_load_dwordx4 v15, s[48:51], s58 offen offset:1024 sc1 lds
    s_add_u32 m0, s67, 12288
    s_mov_b32 s58, 393216
    buffer_load_dwordx4 v14, s[48:51], s58 offen sc1 lds
    buffer_load_dwordx4 v15, s[48:51], s58 offen offset:1024 sc1 lds
    s_mov_b32 s76, 0x3f3504f3
    s_waitcnt lgkmcnt(2)
    v_mfma_f32_16x16x32_bf16 v[240:243], v[200:203], a[192:195], v[240:243]
    s_waitcnt lgkmcnt(0)
    v_mfma_f32_16x16x32_bf16 v[244:247], v[200:203], a[196:199], v[244:247]
    s_waitcnt vmcnt(18)
    ds_read_b64_tr_b16 a[200:201], v238 offset:6144
    ds_read_b64_tr_b16 a[202:203], v238 offset:7168
    ds_read_b64_tr_b16 a[204:205], v239 offset:6144
    ds_read_b64_tr_b16 a[206:207], v239 offset:7168
    s_waitcnt lgkmcnt(2)
    v_mfma_f32_16x16x32_bf16 v[240:243], v[200:203], a[200:203], v[240:243]
    s_waitcnt lgkmcnt(0)
    v_mfma_f32_16x16x32_bf16 v[244:247], v[200:203], a[204:207], v[244:247]
    s_waitcnt vmcnt(16)
    ds_read_b64_tr_b16 a[208:209], v238 offset:8192
    ds_read_b64_tr_b16 a[210:211], v238 offset:9216
    ds_read_b64_tr_b16 a[212:213], v239 offset:8192
    ds_read_b64_tr_b16 a[214:215], v239 offset:9216
    s_waitcnt lgkmcnt(2)
    v_mfma_f32_16x16x32_bf16 v[240:243], v[200:203], a[208:211], v[240:243]
    s_waitcnt lgkmcnt(0)
    v_mfma_f32_16x16x32_bf16 v[244:247], v[200:203], a[212:215], v[244:247]
    s_waitcnt vmcnt(14)
    ds_read_b64_tr_b16 a[216:217], v248 offset:0
    ds_read_b64_tr_b16 a[218:219], v248 offset:1024
    ds_read_b64_tr_b16 a[220:221], v249 offset:0
    ds_read_b64_tr_b16 a[222:223], v249 offset:1024
    v_xor_b32 v238, 32, v132
    v_xor_b32 v239, 32, v133
    v_xor_b32 v248, 32, v134
    v_xor_b32 v249, 32, v135
    v_xor_b32 v252, 32, v136
    v_xor_b32_e64 v253, 32, v137
    s_waitcnt lgkmcnt(2)
    v_mfma_f32_16x16x32_bf16 v[240:243], v[200:203], a[216:219], v[240:243]
    s_waitcnt lgkmcnt(0)
    v_mfma_f32_16x16x32_bf16 v[244:247], v[200:203], a[220:223], v[244:247]
    s_waitcnt vmcnt(12)
    ds_read_b64_tr_b16 v[80:81], v104 offset:0
    ds_read_b64_tr_b16 v[82:83], v104 offset:1024
    ds_read_b64_tr_b16 v[84:85], v105 offset:0
    ds_read_b64_tr_b16 v[86:87], v105 offset:1024
    s_waitcnt lgkmcnt(2)
    v_mfma_f32_32x32x16_bf16 v[16:31], a[0:3], v[80:83], 0
    s_waitcnt vmcnt(10)
    ds_read_b64_tr_b16 v[88:89], v104 offset:2048
    ds_read_b64_tr_b16 v[90:91], v104 offset:3072
    v_mfma_f32_32x32x16_bf16 v[32:47], a[4:7], v[80:83], 0
    s_waitcnt lgkmcnt(2)
    ds_read_b64_tr_b16 v[92:93], v105 offset:2048
    ds_read_b64_tr_b16 v[94:95], v105 offset:3072
    v_mfma_f32_4x4x4_16b_bf16 v[116:119], v[80:81], v[80:81], 0
    v_mfma_f32_4x4x4_16b_bf16 v[120:123], v[84:85], v[84:85], 0
    v_mfma_f32_16x16x32_bf16 v[148:151], v[156:159], v[84:87], 0
    s_add_u32 m0, s74, 2048
    s_add_u32 s68, s8, 0
    buffer_load_dwordx4 v114, s[36:39], s68 offen lds
    v_mfma_f32_4x4x4_16b_bf16 v[116:119], v[82:83], v[82:83], v[116:119]
    v_mfma_f32_4x4x4_16b_bf16 v[120:123], v[86:87], v[86:87], v[120:123]
    v_mfma_f32_16x16x32_bf16 v[148:151], v[152:155], v[80:83], v[148:151]
    s_waitcnt lgkmcnt(2)
    v_mfma_f32_32x32x16_bf16 v[16:31], a[8:11], v[88:91], v[16:31]
    s_waitcnt vmcnt(9)
    ds_read_b64_tr_b16 v[80:81], v104 offset:4096
    ds_read_b64_tr_b16 v[82:83], v104 offset:5120
    v_mfma_f32_32x32x16_bf16 v[32:47], a[12:15], v[88:91], v[32:47]
    s_waitcnt lgkmcnt(2)
    ds_read_b64_tr_b16 v[84:85], v105 offset:4096
    ds_read_b64_tr_b16 v[86:87], v105 offset:5120
    buffer_load_dwordx4 v115, s[36:39], s68 offen offset:1024 lds
    v_mfma_f32_4x4x4_16b_bf16 v[116:119], v[88:89], v[88:89], v[116:119]
    v_mfma_f32_4x4x4_16b_bf16 v[120:123], v[92:93], v[92:93], v[120:123]
    v_mfma_f32_16x16x32_bf16 v[148:151], v[156:159], v[92:95], v[148:151]
    v_mfma_f32_4x4x4_16b_bf16 v[116:119], v[90:91], v[90:91], v[116:119]
    v_mfma_f32_4x4x4_16b_bf16 v[120:123], v[94:95], v[94:95], v[120:123]
    s_add_u32 m0, s74, 4096
    s_add_u32 s68, s8, 14336
    buffer_load_dwordx4 v254, s[36:39], s68 offen lds
    v_mfma_f32_16x16x32_bf16 v[148:151], v[152:155], v[88:91], v[148:151]
    s_waitcnt lgkmcnt(2)
    v_mfma_f32_32x32x16_bf16 v[16:31], a[16:19], v[80:83], v[16:31]
    s_waitcnt vmcnt(9)
    ds_read_b64_tr_b16 v[88:89], v104 offset:6144
    ds_read_b64_tr_b16 v[90:91], v104 offset:7168
    v_mfma_f32_32x32x16_bf16 v[32:47], a[20:23], v[80:83], v[32:47]
    s_waitcnt lgkmcnt(2)
    ds_read_b64_tr_b16 v[92:93], v105 offset:6144
    ds_read_b64_tr_b16 v[94:95], v105 offset:7168
    v_mfma_f32_4x4x4_16b_bf16 v[116:119], v[80:81], v[80:81], v[116:119]
    buffer_load_dwordx4 v255, s[36:39], s68 offen offset:1024 lds
    v_mfma_f32_4x4x4_16b_bf16 v[120:123], v[84:85], v[84:85], v[120:123]
    v_mfma_f32_16x16x32_bf16 v[148:151], v[156:159], v[84:87], v[148:151]
    v_mfma_f32_4x4x4_16b_bf16 v[116:119], v[82:83], v[82:83], v[116:119]
    v_mfma_f32_4x4x4_16b_bf16 v[120:123], v[86:87], v[86:87], v[120:123]
    v_mfma_f32_16x16x32_bf16 v[148:151], v[152:155], v[80:83], v[148:151]
    s_waitcnt lgkmcnt(2)
    s_add_u32 m0, s74, 6144
    s_add_u32 s68, s8, 28672
    buffer_load_dwordx4 v114, s[36:39], s68 offen lds
    v_mfma_f32_32x32x16_bf16 v[16:31], a[24:27], v[88:91], v[16:31]
    s_waitcnt vmcnt(9)
    ds_read_b64_tr_b16 v[80:81], v104 offset:8192
    ds_read_b64_tr_b16 v[82:83], v104 offset:9216
    v_mfma_f32_32x32x16_bf16 v[32:47], a[28:31], v[88:91], v[32:47]
    s_waitcnt lgkmcnt(2)
    ds_read_b64_tr_b16 v[84:85], v105 offset:8192
    ds_read_b64_tr_b16 v[86:87], v105 offset:9216
    v_mfma_f32_4x4x4_16b_bf16 v[116:119], v[88:89], v[88:89], v[116:119]
    buffer_load_dwordx4 v115, s[36:39], s68 offen offset:1024 lds
    v_mfma_f32_4x4x4_16b_bf16 v[120:123], v[92:93], v[92:93], v[120:123]
    v_mfma_f32_16x16x32_bf16 v[148:151], v[156:159], v[92:95], v[148:151]
    v_mfma_f32_4x4x4_16b_bf16 v[116:119], v[90:91], v[90:91], v[116:119]
    v_mfma_f32_4x4x4_16b_bf16 v[120:123], v[94:95], v[94:95], v[120:123]
    v_mfma_f32_16x16x32_bf16 v[148:151], v[152:155], v[88:91], v[148:151]
    s_waitcnt lgkmcnt(2)
    v_mfma_f32_32x32x16_bf16 v[16:31], a[32:35], v[80:83], v[16:31]
    s_waitcnt vmcnt(8)
    ds_read_b64_tr_b16 v[88:89], v104 offset:10240
    ds_read_b64_tr_b16 v[90:91], v104 offset:11264
    v_mfma_f32_32x32x16_bf16 v[32:47], a[36:39], v[80:83], v[32:47]
    s_waitcnt lgkmcnt(2)
    ds_read_b64_tr_b16 v[92:93], v105 offset:10240
    ds_read_b64_tr_b16 v[94:95], v105 offset:11264
    v_mfma_f32_4x4x4_16b_bf16 v[116:119], v[80:81], v[80:81], v[116:119]
    s_add_u32 m0, s74, 8192
    s_add_u32 s68, s8, 43008
    buffer_load_dwordx4 v254, s[36:39], s68 offen lds
    v_mfma_f32_4x4x4_16b_bf16 v[120:123], v[84:85], v[84:85], v[120:123]
    buffer_load_dwordx4 v255, s[36:39], s68 offen offset:1024 lds
    v_mfma_f32_16x16x32_bf16 v[148:151], v[156:159], v[84:87], v[148:151]
    v_mfma_f32_4x4x4_16b_bf16 v[116:119], v[82:83], v[82:83], v[116:119]
    v_mfma_f32_4x4x4_16b_bf16 v[120:123], v[86:87], v[86:87], v[120:123]
    v_mfma_f32_16x16x32_bf16 v[148:151], v[152:155], v[80:83], v[148:151]
    s_waitcnt lgkmcnt(2)
    v_mfma_f32_32x32x16_bf16 v[16:31], a[40:43], v[88:91], v[16:31]
    s_waitcnt vmcnt(8)
    s_barrier
    ds_read_b64_tr_b16 v[80:81], v104 offset:12288
    ds_read_b64_tr_b16 v[82:83], v104 offset:13312
    v_mfma_f32_32x32x16_bf16 v[32:47], a[44:47], v[88:91], v[32:47]
    s_waitcnt lgkmcnt(2)
    ds_read_b64_tr_b16 v[84:85], v105 offset:12288
    ds_read_b64_tr_b16 v[86:87], v105 offset:13312
    v_mfma_f32_4x4x4_16b_bf16 v[116:119], v[88:89], v[88:89], v[116:119]
    s_add_u32 m0, s74, 10240
    s_add_u32 s68, s9, 0
    buffer_load_dwordx4 v114, s[36:39], s68 offen lds
    v_mfma_f32_4x4x4_16b_bf16 v[120:123], v[92:93], v[92:93], v[120:123]
    v_mfma_f32_16x16x32_bf16 v[148:151], v[156:159], v[92:95], v[148:151]
    buffer_load_dwordx4 v115, s[36:39], s68 offen offset:1024 lds
    v_mfma_f32_4x4x4_16b_bf16 v[116:119], v[90:91], v[90:91], v[116:119]
    v_mfma_f32_4x4x4_16b_bf16 v[120:123], v[94:95], v[94:95], v[120:123]
    v_mfma_f32_16x16x32_bf16 v[148:151], v[152:155], v[88:91], v[148:151]
    s_waitcnt lgkmcnt(2)
    v_mfma_f32_32x32x16_bf16 v[16:31], a[48:51], v[80:83], v[16:31]
    ds_read_b64_tr_b16 v[88:89], v106 offset:0
    ds_read_b64_tr_b16 v[90:91], v106 offset:1024
    v_mfma_f32_32x32x16_bf16 v[32:47], a[52:55], v[80:83], v[32:47]
    s_waitcnt lgkmcnt(2)
    ds_read_b64_tr_b16 v[92:93], v106 offset:2048
    ds_read_b64_tr_b16 v[94:95], v106 offset:3072
    v_mfma_f32_4x4x4_16b_bf16 v[116:119], v[80:81], v[80:81], v[116:119]
    s_add_u32 m0, s74, 12288
    s_add_u32 s68, s9, 14336
    buffer_load_dwordx4 v254, s[36:39], s68 offen lds
    v_mfma_f32_4x4x4_16b_bf16 v[120:123], v[84:85], v[84:85], v[120:123]
    v_mfma_f32_16x16x32_bf16 v[148:151], v[156:159], v[84:87], v[148:151]
    v_mfma_f32_4x4x4_16b_bf16 v[116:119], v[82:83], v[82:83], v[116:119]
    buffer_load_dwordx4 v255, s[36:39], s68 offen offset:1024 lds
    v_mfma_f32_4x4x4_16b_bf16 v[120:123], v[86:87], v[86:87], v[120:123]
    v_mfma_f32_16x16x32_bf16 v[148:151], v[152:155], v[80:83], v[148:151]
    s_waitcnt lgkmcnt(2)
    v_mfma_f32_32x32x16_bf16 v[16:31], a[56:59], v[88:91], v[16:31]
    s_lshl_b32 s58, s54, 3
    ds_read_b64_tr_b16 v[80:81], v106 offset:4096
    ds_read_b64_tr_b16 v[82:83], v106 offset:5120
    v_lshlrev_b32_e64 v14, 5, v1
    v_add_u32 v14, 158720, v14
    v_add_u32_e64 v15, s58, v14
    v_mov_b32 v99, 0
    v_mfma_f32_32x32x16_bf16 v[32:47], a[60:63], v[88:91], v[32:47]
    s_waitcnt lgkmcnt(2)
    s_mov_b32 vcc_lo, 0xaaaaaaaa
    s_mov_b32 vcc_hi, 0xaaaaaaaa
    v_mov_b32 v12, v148
    v_cndmask_b32 v116, v116, v117, vcc
    v_cndmask_b32 v118, v118, v119, vcc
    v_cndmask_b32 v120, v120, v121, vcc
    v_mfma_f32_32x32x16_bf16 v[16:31], a[64:67], v[92:95], v[16:31]
    ds_read_b64_tr_b16 v[84:85], v106 offset:6144
    ds_read_b64_tr_b16 v[86:87], v106 offset:7168
    s_add_u32 m0, s75, 0
    s_add_u32 s68, s9, 28672
    buffer_load_dwordx4 v114, s[36:39], s68 offen lds
    v_mfma_f32_32x32x16_bf16 v[32:47], a[68:71], v[92:95], v[32:47]
    s_waitcnt lgkmcnt(2)
    v_cndmask_b32_e64 v122, v122, v123, vcc
    s_mov_b32 vcc_lo, 0xcccccccc
    s_mov_b32 vcc_hi, 0xcccccccc
    v_cndmask_b32 v116, v116, v118, vcc
    v_cndmask_b32 v120, v120, v122, vcc
    s_nop 1
    v_permlane32_swap_b32 v116, v120
    v_mfma_f32_32x32x16_bf16 v[16:31], a[72:75], v[80:83], v[16:31]
    ds_read_b64_tr_b16 v[88:89], v106 offset:8192
    ds_read_b64_tr_b16 v[90:91], v106 offset:9216
    buffer_load_dwordx4 v115, s[36:39], s68 offen offset:1024 lds
    v_add_f32 v13, v116, v120
    v_mov_b32 v103, 0
    v_cvt_pk_bf16_f32 v2, v240, v240
    v_mfma_f32_32x32x16_bf16 v[32:47], a[76:79], v[80:83], v[32:47]
    s_waitcnt lgkmcnt(2)
    ds_write_b64 v15, v[12:13]
    v_and_b32 v3, 0xffff0000, v2
    v_sub_f32 v3, v240, v3
    v_mov_b32_e64 v240, v2
    v_cvt_pk_bf16_f32 v241, v3, v3
    v_mfma_f32_32x32x16_bf16 v[16:31], a[80:83], v[84:87], v[16:31]
    ds_read_b64_tr_b16 v[92:93], v106 offset:10240
    ds_read_b64_tr_b16 v[94:95], v106 offset:11264
    v_lshl_or_b32 v242, v204, 16, v204
    v_mov_b32 v243, 0
    v_cvt_pk_bf16_f32 v2, v244, v244
    v_and_b32 v3, 0xffff0000, v2
    v_mfma_f32_32x32x16_bf16 v[32:47], a[84:87], v[84:87], v[32:47]
    s_waitcnt lgkmcnt(3)
    s_add_u32 m0, s75, 2048
    s_add_u32 s68, s9, 43008
    buffer_load_dwordx4 v254, s[36:39], s68 offen lds
    v_sub_f32 v3, v244, v3
    v_mfma_f32_32x32x16_bf16 v[16:31], a[88:91], v[88:91], v[16:31]
    s_waitcnt lgkmcnt(2)
    ds_read_b64_tr_b16 v[80:81], v106 offset:12288
    ds_read_b64_tr_b16 v[82:83], v106 offset:13312
    s_barrier
    v_mfma_f32_32x32x16_bf16 v[32:47], a[92:95], v[88:91], v[32:47]
    s_waitcnt lgkmcnt(2)
    buffer_load_dwordx4 v255, s[36:39], s68 offen offset:1024 lds
    ds_read_b128 v[4:7], v14
    ds_read_b128 v[8:11], v14 offset:16
    v_mov_b32_e64 v244, v2
    v_cvt_pk_bf16_f32 v245, v3, v3
    v_mfma_f32_32x32x16_bf16 v[16:31], a[96:99], v[92:95], v[16:31]
    ds_read_b64_tr_b16 v[84:85], v108 offset:0
    ds_read_b64_tr_b16 v[86:87], v108 offset:1024
    v_lshl_or_b32 v246, v205, 16, v205
    v_mov_b32 v247, 0
    v_mfma_f32_32x32x16_bf16 v[32:47], a[100:103], v[92:95], v[32:47]
    s_waitcnt lgkmcnt(4)
    v_mfma_f32_32x32x16_bf16 v[16:31], a[104:107], v[80:83], v[16:31]
    ds_read_b64_tr_b16 v[88:89], v108 offset:2048
    ds_read_b64_tr_b16 v[90:91], v108 offset:3072
    s_add_u32 m0, s75, 4096
    s_add_u32 s68, s10, 0
    buffer_load_dwordx4 v114, s[36:39], s68 offen lds
    v_mfma_f32_32x32x16_bf16 v[32:47], a[108:111], v[80:83], v[32:47]
    s_waitcnt lgkmcnt(2)
    v_add_f32 v4, v4, v6
    v_add_f32 v5, v5, v7
    v_add_f32 v8, v8, v10
    v_add_f32 v9, v9, v11
    v_add_f32 v4, v4, v8
    v_add_f32 v5, v5, v9
    v_mfma_f32_32x32x16_bf16 v[16:31], a[112:115], v[84:87], v[16:31]
    ds_read_b64_tr_b16 v[92:93], v108 offset:4096
    ds_read_b64_tr_b16 v[94:95], v108 offset:5120
    buffer_load_dwordx4 v115, s[36:39], s68 offen offset:1024 lds
    v_mul_f32 v4, 0xbb124925, v4
    v_mul_f32 v5, 0x3b124925, v5
    v_fma_f32 v5, -v4, v4, v5
    v_mfma_f32_32x32x16_bf16 v[32:47], a[116:119], v[84:87], v[32:47]
    s_waitcnt lgkmcnt(2)
    v_max_f32 v5, 0, v5
    v_add_f32 v5, 0x3727c5ac, v5
    v_rsq_f32_e64 v6, v5
    v_cvt_pk_bf16_f32 v7, v4, v4
    v_and_b32 v7, 0xffff0000, v7
    v_mfma_f32_32x32x16_bf16 v[16:31], a[120:123], v[88:91], v[16:31]
    ds_read_b64_tr_b16 v[80:81], v108 offset:6144
    ds_read_b64_tr_b16 v[82:83], v108 offset:7168
    v_mul_f32_e64 v5, v5, v6
    v_sub_f32 v4, v4, v7
    v_mul_f32 v112, 0x3fb8aa3b, v6
    v_cvt_pk_bf16_f32 v8, v5, v5
    v_mfma_f32_32x32x16_bf16 v[32:47], a[124:127], v[88:91], v[32:47]
    s_waitcnt lgkmcnt(2)
    s_add_u32 m0, s75, 6144
    s_add_u32 s68, s10, 14336
    buffer_load_dwordx4 v254, s[36:39], s68 offen lds
    v_cvt_pk_bf16_f32 v4, v7, v4
    v_mfma_f32_32x32x16_bf16 v[16:31], a[128:131], v[92:95], v[16:31]
    ds_read_b64_tr_b16 v[84:85], v108 offset:8192
    ds_read_b64_tr_b16 v[86:87], v108 offset:9216
    v_and_b32 v8, 0xffff0000, v8
    v_mov_b32 v113, v112
    v_sub_f32 v5, v5, v8
    v_mfma_f32_32x32x16_bf16 v[32:47], a[132:135], v[92:95], v[32:47]
    s_waitcnt lgkmcnt(2)
    buffer_load_dwordx4 v255, s[36:39], s68 offen offset:1024 lds
    s_mov_b32 vcc_lo, -1
    s_mov_b32 vcc_hi, 0
    v_cndmask_b32 v96, 0, v4, vcc
    v_cndmask_b32_e64 v97, 0, v4, vcc
    v_mfma_f32_32x32x16_bf16 v[16:31], a[136:139], v[80:83], v[16:31]
    ds_read_b64_tr_b16 v[88:89], v108 offset:10240
    ds_read_b64_tr_b16 v[90:91], v108 offset:11264
    v_cvt_pk_bf16_f32 v5, v8, v5
    v_permlane32_swap_b32 v112, v113
    v_cndmask_b32 v98, 0, v5, vcc
    v_sub_u32_e64 v100, v4, v96
    v_mfma_f32_32x32x16_bf16 v[32:47], a[140:143], v[80:83], v[32:47]
    s_branch SKIP4
PAD4:
    s_branch HOPBACK
SKIP4:
    s_waitcnt lgkmcnt(2)
    v_sub_u32 v101, v4, v96
    v_sub_u32_e64 v102, v5, v98
    v_mfma_f32_32x32x16_bf16 v[16:31], a[144:147], v[84:87], v[16:31]
    ds_read_b64_tr_b16 v[92:93], v108 offset:12288
    ds_read_b64_tr_b16 v[94:95], v108 offset:13312
    s_add_u32 m0, s75, 8192
    s_add_u32 s68, s10, 28672
    buffer_load_dwordx4 v114, s[36:39], s68 offen lds
    v_mfma_f32_32x32x16_bf16 v[32:47], a[148:151], v[84:87], v[32:47]
    s_waitcnt lgkmcnt(2)
    s_waitcnt vmcnt(17)
    ds_read_b64_tr_b16 a[224:225], v134 offset:2048
    ds_read_b64_tr_b16 a[226:227], v134 offset:3072
    ds_read_b64_tr_b16 a[228:229], v248 offset:2048
    ds_read_b64_tr_b16 a[230:231], v248 offset:3072
    ds_read_b64_tr_b16 a[232:233], v135 offset:2048
    v_mfma_f32_32x32x16_bf16 v[16:31], a[152:155], v[88:91], v[16:31]
    ds_read_b64_tr_b16 v[80:81], v110 offset:0
    ds_read_b64_tr_b16 v[82:83], v110 offset:1024
    buffer_load_dwordx4 v115, s[36:39], s68 offen offset:1024 lds
    ds_read_b64_tr_b16 a[234:235], v135 offset:3072
    ds_read_b64_tr_b16 a[236:237], v249 offset:2048
    ds_read_b64_tr_b16 a[238:239], v249 offset:3072
    v_mfma_f32_32x32x16_bf16 v[32:47], a[156:159], v[88:91], v[32:47]
    s_waitcnt lgkmcnt(10)
    v_mfma_f32_32x32x16_bf16 v[16:31], a[160:163], v[92:95], v[16:31]
    ds_read_b64_tr_b16 v[84:85], v110 offset:2048
    ds_read_b64_tr_b16 v[86:87], v110 offset:3072
    v_mfma_f32_32x32x16_bf16 v[32:47], a[164:167], v[92:95], v[32:47]
    s_waitcnt lgkmcnt(5)
    s_add_u32 m0, s74, 0
    s_add_u32 s68, s10, 43008
    buffer_load_dwordx4 v254, s[36:39], s68 offen lds
    v_mfma_f32_32x32x16_bf16 v[16:31], a[168:171], v[80:83], v[16:31]
    ds_read_b64_tr_b16 v[88:89], v110 offset:4096
    ds_read_b64_tr_b16 v[90:91], v110 offset:5120
    v_mfma_f32_32x32x16_bf16 v[32:47], a[172:175], v[80:83], v[32:47]
    s_waitcnt lgkmcnt(2)
    buffer_load_dwordx4 v255, s[36:39], s68 offen offset:1024 lds
    v_mfma_f32_32x32x16_bf16 v[16:31], a[176:179], v[84:87], v[16:31]
    ds_read_b64_tr_b16 v[92:93], v110 offset:6144
    ds_read_b64_tr_b16 v[94:95], v110 offset:7168
    v_mfma_f32_32x32x16_bf16 v[32:47], a[180:183], v[84:87], v[32:47]
    s_waitcnt lgkmcnt(2)
    v_mfma_f32_32x32x16_bf16 v[16:31], a[184:187], v[88:91], v[16:31]
    ds_read_b64_tr_b16 v[80:81], v110 offset:8192
    ds_read_b64_tr_b16 v[82:83], v110 offset:9216
    s_add_u32 m0, s74, 2048
    s_add_u32 s68, s11, 0
    buffer_load_dwordx4 v114, s[36:39], s68 offen lds
    v_mfma_f32_32x32x16_bf16 v[32:47], a[188:191], v[88:91], v[32:47]
    s_waitcnt lgkmcnt(2)
    s_waitcnt vmcnt(17)
    ds_read_b64_tr_b16 a[240:241], v134 offset:6144
    ds_read_b64_tr_b16 a[242:243], v134 offset:7168
    ds_read_b64_tr_b16 a[244:245], v248 offset:6144
    ds_read_b64_tr_b16 a[246:247], v248 offset:7168
    ds_read_b64_tr_b16 a[248:249], v135 offset:6144
    v_mfma_f32_32x32x16_bf16 v[16:31], a[192:195], v[92:95], v[16:31]
    ds_read_b64_tr_b16 v[84:85], v110 offset:10240
    ds_read_b64_tr_b16 v[86:87], v110 offset:11264
    buffer_load_dwordx4 v115, s[36:39], s68 offen offset:1024 lds
    ds_read_b64_tr_b16 a[250:251], v135 offset:7168
    ds_read_b64_tr_b16 a[252:253], v249 offset:6144
    ds_read_b64_tr_b16 a[254:255], v249 offset:7168
    v_mfma_f32_32x32x16_bf16 v[32:47], a[196:199], v[92:95], v[32:47]
    s_waitcnt lgkmcnt(10)
    v_mfma_f32_32x32x16_bf16 v[16:31], a[200:203], v[80:83], v[16:31]
    ds_read_b64_tr_b16 v[88:89], v110 offset:12288
    ds_read_b64_tr_b16 v[90:91], v110 offset:13312
    v_mfma_f32_32x32x16_bf16 v[32:47], a[204:207], v[80:83], v[32:47]
    s_waitcnt lgkmcnt(5)
    s_add_u32 m0, s74, 4096
    s_add_u32 s68, s11, 14336
    buffer_load_dwordx4 v254, s[36:39], s68 offen lds
    v_mfma_f32_32x32x16_bf16 v[16:31], a[208:211], v[84:87], v[16:31]
    ds_read_b64_tr_b16 v[92:93], v105 offset:0
    ds_read_b64_tr_b16 v[94:95], v105 offset:1024
    v_mfma_f32_32x32x16_bf16 v[32:47], a[212:215], v[84:87], v[32:47]
    s_waitcnt lgkmcnt(2)
    buffer_load_dwordx4 v255, s[36:39], s68 offen offset:1024 lds
    v_mfma_f32_32x32x16_bf16 v[16:31], a[216:219], v[88:91], v[16:31]
    ds_read_b64_tr_b16 v[80:81], v105 offset:2048
    ds_read_b64_tr_b16 v[82:83], v105 offset:3072
    v_mfma_f32_32x32x16_bf16 v[32:47], a[220:223], v[88:91], v[32:47]
    s_waitcnt lgkmcnt(2)
    v_mfma_f32_32x32x16_bf16 v[16:31], v[240:243], v[96:99], v[16:31]
    s_add_u32 m0, s74, 6144
    s_add_u32 s68, s11, 28672
    buffer_load_dwordx4 v114, s[36:39], s68 offen lds
    v_mfma_f32_32x32x16_bf16 v[32:47], v[244:247], v[96:99], v[32:47]
    s_waitcnt vmcnt(17)
    ds_read_b64_tr_b16 v[160:161], v134 offset:10240
    ds_read_b64_tr_b16 v[162:163], v134 offset:11264
    ds_read_b64_tr_b16 v[164:165], v248 offset:10240
    ds_read_b64_tr_b16 v[166:167], v248 offset:11264
    ds_read_b64_tr_b16 v[168:169], v135 offset:10240
    ds_read_b64_tr_b16 v[170:171], v135 offset:11264
    v_mfma_f32_32x32x16_bf16 v[48:63], a[0:3], v[92:95], 0
    ds_read_b64_tr_b16 v[84:85], v105 offset:4096
    ds_read_b64_tr_b16 v[86:87], v105 offset:5120
    buffer_load_dwordx4 v115, s[36:39], s68 offen offset:1024 lds
    ds_read_b64_tr_b16 v[172:173], v249 offset:10240
    ds_read_b64_tr_b16 v[174:175], v249 offset:11264
    v_mul_f32 v16, v112, v16
    v_mfma_f32_32x32x16_bf16 v[64:79], a[4:7], v[92:95], 0
    s_waitcnt lgkmcnt(10)
    v_mul_f32 v17, v112, v17
    v_mul_f32 v18, v112, v18
    v_mul_f32 v19, v112, v19
    v_exp_f32_e64 v4, v16
    v_mfma_f32_32x32x16_bf16 v[48:63], a[8:11], v[80:83], v[48:63]
    ds_read_b64_tr_b16 v[88:89], v105 offset:6144
    ds_read_b64_tr_b16 v[90:91], v105 offset:7168
    v_exp_f32_e64 v5, v17
    v_exp_f32 v6, v18
    v_mfma_f32_32x32x16_bf16 v[64:79], a[12:15], v[80:83], v[64:79]
    s_waitcnt lgkmcnt(4)
    s_add_u32 m0, s74, 8192
    s_add_u32 s68, s11, 43008
    buffer_load_dwordx4 v254, s[36:39], s68 offen lds
    v_mfma_f32_32x32x16_bf16 v[48:63], a[16:19], v[84:87], v[48:63]
    ds_read_b64_tr_b16 v[92:93], v105 offset:8192
    ds_read_b64_tr_b16 v[94:95], v105 offset:9216
    v_exp_f32 v7, v19
    v_fma_f32 v4, v4, s76, s76
    v_fma_f32 v5, v5, s76, s76
    v_mfma_f32_32x32x16_bf16 v[64:79], a[20:23], v[84:87], v[64:79]
    s_waitcnt lgkmcnt(2)
    buffer_load_dwordx4 v255, s[36:39], s68 offen offset:1024 lds
    v_fma_f32 v6, v6, s76, s76
    v_fma_f32 v7, v7, s76, s76
    v_fma_f32 v4, v4, v4, 0.5
    v_fma_f32 v5, v5, v5, 0.5
    v_mfma_f32_32x32x16_bf16 v[48:63], a[24:27], v[88:91], v[48:63]
    ds_read_b64_tr_b16 v[80:81], v105 offset:10240
    ds_read_b64_tr_b16 v[82:83], v105 offset:11264
    v_fma_f32 v6, v6, v6, 0.5
    v_fma_f32 v7, v7, v7, 0.5
    v_rcp_f32_e64 v4, v4
    v_mfma_f32_32x32x16_bf16 v[64:79], a[28:31], v[88:91], v[64:79]
    s_waitcnt lgkmcnt(2)
    v_rcp_f32 v5, v5
    v_rcp_f32_e64 v6, v6
    v_rcp_f32 v7, v7
    v_mfma_f32_32x32x16_bf16 v[48:63], a[32:35], v[92:95], v[48:63]
    ds_read_b64_tr_b16 v[84:85], v105 offset:12288
    ds_read_b64_tr_b16 v[86:87], v105 offset:13312
    s_add_u32 m0, s74, 10240
    s_add_u32 s68, s12, 0
    buffer_load_dwordx4 v114, s[36:39], s68 offen lds
    v_mfma_f32_32x32x16_bf16 v[64:79], a[36:39], v[92:95], v[64:79]
    s_waitcnt lgkmcnt(2)
    s_waitcnt vmcnt(17)
    ds_read_b64_tr_b16 v[176:177], v132 offset:0
    ds_read_b64_tr_b16 v[178:179], v132 offset:1024
    ds_read_b64_tr_b16 v[180:181], v238 offset:0
    ds_read_b64_tr_b16 v[182:183], v238 offset:1024
    ds_read_b64_tr_b16 v[184:185], v133 offset:0
    v_mfma_f32_32x32x16_bf16 v[48:63], a[40:43], v[80:83], v[48:63]
    ds_read_b64_tr_b16 v[88:89], v107 offset:0
    ds_read_b64_tr_b16 v[90:91], v107 offset:1024
    buffer_load_dwordx4 v115, s[36:39], s68 offen offset:1024 lds
    ds_read_b64_tr_b16 v[186:187], v133 offset:1024
    ds_read_b64_tr_b16 v[188:189], v239 offset:0
    ds_read_b64_tr_b16 v[190:191], v239 offset:1024
    v_mfma_f32_32x32x16_bf16 v[64:79], a[44:47], v[80:83], v[64:79]
    s_waitcnt lgkmcnt(10)
    v_fma_f32 v4, -v16, v4, v16
    v_fma_f32 v5, -v17, v5, v17
    v_fma_f32 v6, -v18, v6, v18
    v_fma_f32 v7, -v19, v7, v19
    v_cvt_pk_bf16_f32 v16, v4, v5
    v_cvt_pk_bf16_f32 v17, v6, v7
    v_mfma_f32_32x32x16_bf16 v[48:63], a[48:51], v[84:87], v[48:63]
    ds_read_b64_tr_b16 v[92:93], v107 offset:2048
    ds_read_b64_tr_b16 v[94:95], v107 offset:3072
    v_mul_f32 v20, v112, v20
    v_mul_f32 v21, v112, v21
    v_mul_f32 v22, v112, v22
    v_mul_f32 v23, v112, v23
    v_mfma_f32_32x32x16_bf16 v[64:79], a[52:55], v[84:87], v[64:79]
    s_waitcnt lgkmcnt(5)
    s_add_u32 m0, s74, 12288
    s_add_u32 s68, s12, 14336
    buffer_load_dwordx4 v254, s[36:39], s68 offen lds
    v_mfma_f32_32x32x16_bf16 v[48:63], a[56:59], v[88:91], v[48:63]
    ds_read_b64_tr_b16 v[80:81], v107 offset:4096
    ds_read_b64_tr_b16 v[82:83], v107 offset:5120
    v_exp_f32 v8, v20
    v_exp_f32 v9, v21
    v_mfma_f32_32x32x16_bf16 v[64:79], a[60:63], v[88:91], v[64:79]
    s_waitcnt lgkmcnt(2)
    buffer_load_dwordx4 v255, s[36:39], s68 offen offset:1024 lds
    v_exp_f32 v10, v22
    v_exp_f32_e64 v11, v23
    v_mfma_f32_32x32x16_bf16 v[48:63], a[64:67], v[92:95], v[48:63]
    ds_read_b64_tr_b16 v[84:85], v107 offset:6144
    ds_read_b64_tr_b16 v[86:87], v107 offset:7168
    v_fma_f32 v8, v8, s76, s76
    v_fma_f32 v9, v9, s76, s76
    v_fma_f32 v10, v10, s76, s76
    v_fma_f32 v11, v11, s76, s76
    v_mfma_f32_32x32x16_bf16 v[64:79], a[68:71], v[92:95], v[64:79]
    s_waitcnt lgkmcnt(2)
    v_fma_f32 v8, v8, v8, 0.5
    v_fma_f32 v9, v9, v9, 0.5
    v_fma_f32 v10, v10, v10, 0.5
    v_fma_f32 v11, v11, v11, 0.5
    v_rcp_f32_e64 v8, v8
    v_mfma_f32_32x32x16_bf16 v[48:63], a[72:75], v[80:83], v[48:63]
    ds_read_b64_tr_b16 v[88:89], v107 offset:8192
    ds_read_b64_tr_b16 v[90:91], v107 offset:9216
    s_add_u32 m0, s75, 0
    s_add_u32 s68, s12, 28672
    buffer_load_dwordx4 v114, s[36:39], s68 offen lds
    v_mfma_f32_32x32x16_bf16 v[64:79], a[76:79], v[80:83], v[64:79]
    s_waitcnt lgkmcnt(2)
    s_waitcnt vmcnt(17)
    ds_read_b64_tr_b16 v[192:193], v132 offset:4096
    ds_read_b64_tr_b16 v[194:195], v132 offset:5120
    ds_read_b64_tr_b16 v[196:197], v238 offset:4096
    ds_read_b64_tr_b16 v[198:199], v238 offset:5120
    ds_read_b64_tr_b16 v[206:207], v133 offset:4096
    v_mfma_f32_32x32x16_bf16 v[48:63], a[80:83], v[84:87], v[48:63]
    ds_read_b64_tr_b16 v[92:93], v107 offset:10240
    ds_read_b64_tr_b16 v[94:95], v107 offset:11264
    buffer_load_dwordx4 v115, s[36:39], s68 offen offset:1024 lds
    ds_read_b64_tr_b16 v[208:209], v133 offset:5120
    ds_read_b64_tr_b16 v[210:211], v239 offset:4096
    ds_read_b64_tr_b16 v[212:213], v239 offset:5120
    v_mfma_f32_32x32x16_bf16 v[64:79], a[84:87], v[84:87], v[64:79]
    s_waitcnt lgkmcnt(10)
    v_rcp_f32 v9, v9
    v_rcp_f32 v10, v10
    v_rcp_f32 v11, v11
    v_mfma_f32_32x32x16_bf16 v[48:63], a[88:91], v[88:91], v[48:63]
    ds_read_b64_tr_b16 v[80:81], v107 offset:12288
    ds_read_b64_tr_b16 v[82:83], v107 offset:13312
    v_fma_f32 v8, -v20, v8, v20
    v_fma_f32 v9, -v21, v9, v21
    v_fma_f32 v10, -v22, v10, v22
    v_fma_f32 v11, -v23, v11, v23
    v_mfma_f32_32x32x16_bf16 v[64:79], a[92:95], v[88:91], v[64:79]
    s_waitcnt lgkmcnt(5)
    s_add_u32 m0, s75, 2048
    s_add_u32 s68, s12, 43008
    buffer_load_dwordx4 v254, s[36:39], s68 offen lds
    v_cvt_pk_bf16_f32 v18, v8, v9
    v_mfma_f32_32x32x16_bf16 v[48:63], a[96:99], v[92:95], v[48:63]
    ds_read_b64_tr_b16 v[84:85], v109 offset:0
    ds_read_b64_tr_b16 v[86:87], v109 offset:1024
    v_cvt_pk_bf16_f32 v19, v10, v11
    v_mfma_f32_32x32x16_bf16 v[64:79], a[100:103], v[92:95], v[64:79]
    s_waitcnt lgkmcnt(2)
    buffer_load_dwordx4 v255, s[36:39], s68 offen offset:1024 lds
    v_mfma_f32_32x32x16_bf16 v[48:63], a[104:107], v[80:83], v[48:63]
    ds_read_b64_tr_b16 v[88:89], v109 offset:2048
    ds_read_b64_tr_b16 v[90:91], v109 offset:3072
    v_mfma_f32_32x32x16_bf16 v[64:79], a[108:111], v[80:83], v[64:79]
    s_waitcnt lgkmcnt(2)
    s_cmp_lg_u32 s27, 0
    s_cbranch_scc0 rem_25
    buffer_store_dwordx4 v[16:19], v138, s[48:51], s16 offen offset:0 nt
back_26:
    v_mfma_f32_32x32x16_bf16 v[48:63], a[112:115], v[84:87], v[48:63]
    s_waitcnt vmcnt(17)
    ds_read_b64_tr_b16 v[92:93], v109 offset:4096
    ds_read_b64_tr_b16 v[94:95], v109 offset:5120
    ds_read_b64_tr_b16 v[214:215], v136 offset:8192
    ds_read_b64_tr_b16 v[216:217], v136 offset:9216
    ds_read_b64_tr_b16 v[218:219], v252 offset:8192
    ds_read_b64_tr_b16 v[220:221], v252 offset:9216
    v_mfma_f32_32x32x16_bf16 v[64:79], a[116:119], v[84:87], v[64:79]
    s_waitcnt lgkmcnt(6)
    ds_read_b64_tr_b16 v[222:223], v137 offset:8192
    ds_read_b64_tr_b16 v[224:225], v137 offset:9216
    ds_read_b64_tr_b16 v[226:227], v253 offset:8192
    ds_read_b64_tr_b16 v[228:229], v253 offset:9216
    v_mul_f32 v24, v112, v24
    v_mul_f32_e64 v25, v112, v25
    v_mfma_f32_32x32x16_bf16 v[48:63], a[120:123], v[88:91], v[48:63]
    ds_read_b64_tr_b16 v[80:81], v109 offset:6144
    ds_read_b64_tr_b16 v[82:83], v109 offset:7168
    v_mul_f32 v26, v112, v26
    v_mul_f32 v27, v112, v27
    v_exp_f32_e64 v4, v24
    v_mfma_f32_32x32x16_bf16 v[64:79], a[124:127], v[88:91], v[64:79]
    s_waitcnt lgkmcnt(10)
    v_exp_f32 v5, v25
    v_exp_f32 v6, v26
    v_exp_f32 v7, v27
    v_mfma_f32_32x32x16_bf16 v[48:63], a[128:131], v[92:95], v[48:63]
    ds_read_b64_tr_b16 v[84:85], v109 offset:8192
    ds_read_b64_tr_b16 v[86:87], v109 offset:9216
    s_add_u32 m0, s75, 4096
    s_add_u32 s68, s13, 0
    buffer_load_dwordx4 v114, s[36:39], s68 offen lds
    v_mfma_f32_32x32x16_bf16 v[64:79], a[132:135], v[92:95], v[64:79]
    s_waitcnt lgkmcnt(2)
    v_fma_f32 v4, v4, s76, s76
    v_fma_f32 v5, v5, s76, s76
    v_fma_f32 v6, v6, s76, s76
    v_fma_f32 v7, v7, s76, s76
    v_fma_f32 v4, v4, v4, 0.5
    v_fma_f32 v5, v5, v5, 0.5
    v_mfma_f32_32x32x16_bf16 v[48:63], a[136:139], v[80:83], v[48:63]
    ds_read_b64_tr_b16 v[88:89], v109 offset:10240
    ds_read_b64_tr_b16 v[90:91], v109 offset:11264
    buffer_load_dwordx4 v115, s[36:39], s68 offen offset:1024 lds
    v_fma_f32 v6, v6, v6, 0.5
    v_fma_f32 v7, v7, v7, 0.5
    v_mfma_f32_32x32x16_bf16 v[64:79], a[140:143], v[80:83], v[64:79]
    s_waitcnt lgkmcnt(2)
    v_rcp_f32 v4, v4
    v_rcp_f32 v5, v5
    v_rcp_f32 v6, v6
    v_mfma_f32_32x32x16_bf16 v[48:63], a[144:147], v[84:87], v[48:63]
    ds_read_b64_tr_b16 v[92:93], v109 offset:12288
    ds_read_b64_tr_b16 v[94:95], v109 offset:13312
    v_rcp_f32 v7, v7
    v_fma_f32 v4, -v24, v4, v24
    v_fma_f32 v5, -v25, v5, v25
    v_mfma_f32_32x32x16_bf16 v[64:79], a[148:151], v[84:87], v[64:79]
    s_waitcnt lgkmcnt(2)
    s_add_u32 m0, s75, 6144
    s_add_u32 s68, s13, 14336
    buffer_load_dwordx4 v254, s[36:39], s68 offen lds
    v_fma_f32 v6, -v26, v6, v26
    v_mfma_f32_32x32x16_bf16 v[48:63], a[152:155], v[88:91], v[48:63]
    s_waitcnt vmcnt(16)
    ds_read_b64_tr_b16 v[80:81], v111 offset:0
    ds_read_b64_tr_b16 v[82:83], v111 offset:1024
    ds_read_b64_tr_b16 v[230:231], v134 offset:2048
    ds_read_b64_tr_b16 v[232:233], v134 offset:3072
    ds_read_b64_tr_b16 v[234:235], v248 offset:2048
    ds_read_b64_tr_b16 v[236:237], v248 offset:3072
    v_mfma_f32_32x32x16_bf16 v[64:79], a[156:159], v[88:91], v[64:79]
    s_waitcnt lgkmcnt(6)
    buffer_load_dwordx4 v255, s[36:39], s68 offen offset:1024 lds
    ds_read_b64_tr_b16 a[0:1], v135 offset:2048
    ds_read_b64_tr_b16 a[2:3], v135 offset:3072
    ds_read_b64_tr_b16 a[4:5], v249 offset:2048
    ds_read_b64_tr_b16 a[6:7], v249 offset:3072
    v_mfma_f32_32x32x16_bf16 v[48:63], a[160:163], v[92:95], v[48:63]
    ds_read_b64_tr_b16 v[84:85], v111 offset:2048
    ds_read_b64_tr_b16 v[86:87], v111 offset:3072
    v_fma_f32 v7, -v27, v7, v27
    v_cvt_pk_bf16_f32 v20, v4, v5
    v_cvt_pk_bf16_f32 v21, v6, v7
    v_mul_f32_e64 v28, v112, v28
    v_mfma_f32_32x32x16_bf16 v[64:79], a[164:167], v[92:95], v[64:79]
    s_waitcnt lgkmcnt(10)
    v_mul_f32 v29, v112, v29
    v_mul_f32 v30, v112, v30
    v_mul_f32 v31, v112, v31
    v_exp_f32_e64 v8, v28
    v_mfma_f32_32x32x16_bf16 v[48:63], a[168:171], v[80:83], v[48:63]
    ds_read_b64_tr_b16 v[88:89], v111 offset:4096
    ds_read_b64_tr_b16 v[90:91], v111 offset:5120
    s_add_u32 m0, s75, 8192
    s_add_u32 s68, s13, 28672
    buffer_load_dwordx4 v114, s[36:39], s68 offen lds
    v_mfma_f32_32x32x16_bf16 v[64:79], a[172:175], v[80:83], v[64:79]
    s_waitcnt lgkmcnt(2)
    v_exp_f32 v9, v29
    v_exp_f32 v10, v30
    v_exp_f32 v11, v31
    v_mfma_f32_32x32x16_bf16 v[48:63], a[176:179], v[84:87], v[48:63]
    ds_read_b64_tr_b16 v[92:93], v111 offset:6144
    ds_read_b64_tr_b16 v[94:95], v111 offset:7168
    buffer_load_dwordx4 v115, s[36:39], s68 offen offset:1024 lds
    v_fma_f32 v8, v8, s76, s76
    v_fma_f32 v9, v9, s76, s76
    v_fma_f32 v10, v10, s76, s76
    v_mfma_f32_32x32x16_bf16 v[64:79], a[180:183], v[84:87], v[64:79]
    s_waitcnt lgkmcnt(2)
    v_fma_f32 v11, v11, s76, s76
    v_fma_f32 v8, v8, v8, 0.5
    v_fma_f32 v9, v9, v9, 0.5
    v_fma_f32 v10, v10, v10, 0.5
    v_fma_f32 v11, v11, v11, 0.5
    v_mfma_f32_32x32x16_bf16 v[48:63], a[184:187], v[88:91], v[48:63]
    ds_read_b64_tr_b16 v[80:81], v111 offset:8192
    ds_read_b64_tr_b16 v[82:83], v111 offset:9216
    v_rcp_f32 v8, v8
    v_rcp_f32_e64 v9, v9
    v_mfma_f32_32x32x16_bf16 v[64:79], a[188:191], v[88:91], v[64:79]
    s_waitcnt lgkmcnt(2)
    s_add_u32 m0, s74, 0
    s_add_u32 s68, s13, 43008
    buffer_load_dwordx4 v254, s[36:39], s68 offen lds
    v_mfma_f32_32x32x16_bf16 v[48:63], a[192:195], v[92:95], v[48:63]
    s_waitcnt vmcnt(16)
    ds_read_b64_tr_b16 v[84:85], v111 offset:10240
    ds_read_b64_tr_b16 v[86:87], v111 offset:11264
    ds_read_b64_tr_b16 a[8:9], v134 offset:6144
    ds_read_b64_tr_b16 a[10:11], v134 offset:7168
    ds_read_b64_tr_b16 a[12:13], v248 offset:6144
    ds_read_b64_tr_b16 a[14:15], v248 offset:7168
    v_mfma_f32_32x32x16_bf16 v[64:79], a[196:199], v[92:95], v[64:79]
    s_waitcnt lgkmcnt(6)
    buffer_load_dwordx4 v255, s[36:39], s68 offen offset:1024 lds
    ds_read_b64_tr_b16 a[16:17], v135 offset:6144
    ds_read_b64_tr_b16 a[18:19], v135 offset:7168
    ds_read_b64_tr_b16 a[20:21], v249 offset:6144
    ds_read_b64_tr_b16 a[22:23], v249 offset:7168
    v_mfma_f32_32x32x16_bf16 v[48:63], a[200:203], v[80:83], v[48:63]
    ds_read_b64_tr_b16 v[88:89], v111 offset:12288
    ds_read_b64_tr_b16 v[90:91], v111 offset:13312
    v_rcp_f32_e64 v10, v10
    v_rcp_f32 v11, v11
    v_mfma_f32_32x32x16_bf16 v[64:79], a[204:207], v[80:83], v[64:79]
    s_waitcnt lgkmcnt(10)
    v_fma_f32 v8, -v28, v8, v28
    v_fma_f32 v9, -v29, v9, v29
    v_fma_f32 v10, -v30, v10, v30
    v_fma_f32 v11, -v31, v11, v31
    v_cvt_pk_bf16_f32 v22, v8, v9
    v_cvt_pk_bf16_f32 v23, v10, v11
    v_mfma_f32_32x32x16_bf16 v[48:63], a[208:211], v[84:87], v[48:63]
    s_add_u32 m0, s74, 2048
    s_add_u32 s68, s14, 0
    buffer_load_dwordx4 v114, s[36:39], s68 offen lds
    v_mfma_f32_32x32x16_bf16 v[64:79], a[212:215], v[84:87], v[64:79]
    s_waitcnt lgkmcnt(0)
    s_cmp_lg_u32 s27, 0
    s_cbranch_scc0 rem_27
    buffer_store_dwordx4 v[20:23], v138, s[48:51], s16 offen offset:256 nt
back_28:
    v_mfma_f32_32x32x16_bf16 v[48:63], a[216:219], v[88:91], v[48:63]
    s_nop 0
    v_permlane16_swap_b32 v16, v20
    v_permlane16_swap_b32 v17, v21
    v_permlane16_swap_b32 v18, v22
    v_permlane16_swap_b32 v19, v23
    v_mul_f32 v32, v112, v32
    v_mul_f32_e64 v33, v112, v33
    v_mfma_f32_32x32x16_bf16 v[64:79], a[220:223], v[88:91], v[64:79]
    v_mul_f32 v34, v112, v34
    v_mul_f32 v35, v112, v35
    v_exp_f32 v4, v32
    v_exp_f32 v5, v33
    v_mfma_f32_32x32x16_bf16 v[48:63], v[240:243], v[100:103], v[48:63]
    v_exp_f32 v6, v34
    v_exp_f32 v7, v35
    v_fma_f32 v4, v4, s76, s76
    v_fma_f32 v5, v5, s76, s76
    v_mfma_f32_32x32x16_bf16 v[64:79], v[244:247], v[100:103], v[64:79]
    v_fma_f32 v6, v6, s76, s76
    v_fma_f32 v7, v7, s76, s76
    v_fma_f32 v4, v4, v4, 0.5
    v_fma_f32 v5, v5, v5, 0.5
    v_fma_f32 v6, v6, v6, 0.5
    v_fma_f32 v7, v7, v7, 0.5
    v_rcp_f32 v4, v4
    v_rcp_f32 v5, v5
    v_rcp_f32 v6, v6
    v_rcp_f32 v7, v7
    v_fma_f32 v4, -v32, v4, v32
    v_fma_f32 v5, -v33, v5, v33
    v_fma_f32 v6, -v34, v6, v34
    v_fma_f32 v7, -v35, v7, v35
    v_cvt_pk_bf16_f32 v24, v4, v5
    v_cvt_pk_bf16_f32 v25, v6, v7
    v_mul_f32 v36, v112, v36
    v_mul_f32 v37, v112, v37
    v_mul_f32 v38, v112, v38
    v_mul_f32 v39, v112, v39
    v_exp_f32 v8, v36
    v_exp_f32 v9, v37
    v_exp_f32 v10, v38
    v_exp_f32 v11, v39
    v_fma_f32 v8, v8, s76, s76
    v_fma_f32 v9, v9, s76, s76
    v_fma_f32 v10, v10, s76, s76
    v_fma_f32 v11, v11, s76, s76
    v_fma_f32 v8, v8, v8, 0.5
    v_fma_f32 v9, v9, v9, 0.5
    v_fma_f32 v10, v10, v10, 0.5
    v_fma_f32 v11, v11, v11, 0.5
    v_rcp_f32 v8, v8
    v_rcp_f32 v9, v9
    v_rcp_f32 v10, v10
    v_rcp_f32 v11, v11
    v_fma_f32 v8, -v36, v8, v36
    v_fma_f32 v9, -v37, v9, v37
    v_fma_f32 v10, -v38, v10, v38
    v_fma_f32 v11, -v39, v11, v39
    v_cvt_pk_bf16_f32 v26, v8, v9
    v_cvt_pk_bf16_f32 v27, v10, v11
    s_cmp_lg_u32 s27, 0
    s_cbranch_scc0 rem_29
    buffer_store_dwordx4 v[24:27], v138, s[48:51], s16 offen offset:2048 nt
back_30:
    v_mul_f32 v40, v112, v40
    v_mul_f32 v41, v112, v41
    v_mul_f32 v42, v112, v42
    v_mul_f32 v43, v112, v43
    v_exp_f32 v4, v40
    v_exp_f32 v5, v41
    v_exp_f32 v6, v42
    v_exp_f32 v7, v43
    v_fma_f32 v4, v4, s76, s76
    v_fma_f32 v5, v5, s76, s76
    v_fma_f32 v6, v6, s76, s76
    v_fma_f32 v7, v7, s76, s76
    v_fma_f32 v4, v4, v4, 0.5
    v_fma_f32 v5, v5, v5, 0.5
    v_fma_f32 v6, v6, v6, 0.5
    v_fma_f32 v7, v7, v7, 0.5
    v_rcp_f32 v4, v4
    v_rcp_f32 v5, v5
    v_rcp_f32 v6, v6
    v_rcp_f32 v7, v7
    v_fma_f32 v4, -v40, v4, v40
    v_fma_f32 v5, -v41, v5, v41
    v_fma_f32 v6, -v42, v6, v42
    v_fma_f32 v7, -v43, v7, v43
    v_cvt_pk_bf16_f32 v28, v4, v5
    v_cvt_pk_bf16_f32 v29, v6, v7
    v_mul_f32 v44, v112, v44
    v_mul_f32 v45, v112, v45
    v_mul_f32 v46, v112, v46
    v_mul_f32 v47, v112, v47
    v_exp_f32 v8, v44
    v_exp_f32 v9, v45
    v_exp_f32 v10, v46
    v_exp_f32 v11, v47
    v_fma_f32 v8, v8, s76, s76
    v_fma_f32 v9, v9, s76, s76
    v_fma_f32 v10, v10, s76, s76
    v_fma_f32 v11, v11, s76, s76
    v_fma_f32 v8, v8, v8, 0.5
    v_fma_f32 v9, v9, v9, 0.5
    v_fma_f32 v10, v10, v10, 0.5
    v_fma_f32 v11, v11, v11, 0.5
    v_rcp_f32 v8, v8
    v_rcp_f32 v9, v9
    v_rcp_f32 v10, v10
    v_rcp_f32 v11, v11
    v_fma_f32 v8, -v44, v8, v44
    v_fma_f32 v9, -v45, v9, v45
    v_fma_f32 v10, -v46, v10, v46
    v_fma_f32 v11, -v47, v11, v47
    v_cvt_pk_bf16_f32 v30, v8, v9
    v_cvt_pk_bf16_f32 v31, v10, v11
    s_cmp_lg_u32 s27, 0
    s_cbranch_scc0 rem_31
    buffer_store_dwordx4 v[28:31], v138, s[48:51], s16 offen offset:2304 nt
back_32:
    s_lshl_b32 s58, s55, 2
    s_add_u32 s58, s58, s54
    s_lshl_b32 s58, s58, 7
    s_add_u32 s58, s58, 17301504
    s_lshl_b32 s59, s56, 4
    s_add_u32 s59, s59, s58
    v_bfrev_b32 v13, 1
    v_add_u32 v3, 8388608, v251
    v_mov_b32 v12, s57
    v_cmp_eq_u32 vcc, 0, v1
    v_min_u32 v14, 6, v1
    v_lshlrev_b32 v14, 4, v14
    v_cndmask_b32 v13, v13, 0, vcc
    s_add_u32 s62, s58, 131072
    s_add_u32 s63, s59, 131072
    v_add_u32_e64 v96, s74, v251
    v_pk_mul_f32 v[48:49], v[112:113], v[48:49] op_sel:[1,0]
    buffer_load_dwordx4 v115, s[36:39], s68 offen offset:1024 lds
    v_pk_mul_f32 v[50:51], v[112:113], v[50:51] op_sel:[1,0]
    s_add_u32 m0, s74, 4096
    s_add_u32 s68, s14, 14336
    buffer_load_dwordx4 v254, s[36:39], s68 offen lds
    buffer_load_dwordx4 v255, s[36:39], s68 offen offset:1024 lds
    v_exp_f32 v4, v48
    v_exp_f32 v5, v49
    s_add_u32 m0, s74, 6144
    s_add_u32 s68, s14, 28672
    buffer_load_dwordx4 v114, s[36:39], s68 offen lds
    buffer_load_dwordx4 v115, s[36:39], s68 offen offset:1024 lds
    v_exp_f32 v6, v50
    v_exp_f32 v7, v51
    s_add_u32 m0, s74, 8192
    s_add_u32 s68, s14, 43008
    buffer_load_dwordx4 v254, s[36:39], s68 offen lds
    v_pk_fma_f32 v[4:5], v[4:5], s[76:77], s[76:77] op_sel_hi:[1,0,0]
    v_pk_fma_f32 v[6:7], v[6:7], s[76:77], s[76:77] op_sel_hi:[1,0,0]
    v_pk_fma_f32 v[4:5], v[4:5], v[4:5], s[64:65] op_sel_hi:[1,1,0]
    v_pk_fma_f32 v[6:7], v[6:7], v[6:7], s[64:65] op_sel_hi:[1,1,0]
    v_rcp_f32 v4, v4
    v_rcp_f32 v5, v5
    v_rcp_f32 v6, v6
    v_rcp_f32 v7, v7
    buffer_load_dwordx4 v255, s[36:39], s68 offen offset:1024 lds
    v_pk_fma_f32 v[4:5], v[48:49], v[4:5], v[48:49] neg_lo:[1,0,0] neg_hi:[1,0,0]
    v_pk_fma_f32 v[6:7], v[50:51], v[6:7], v[50:51] neg_lo:[1,0,0] neg_hi:[1,0,0]
    v_cvt_pk_bf16_f32 v48, v4, v5
    v_cvt_pk_bf16_f32 v49, v6, v7
    s_waitcnt vmcnt(7)
    s_cmp_lg_u32 s27, 0
    s_cbranch_scc0 rem_21
    buffer_store_dword v12, v13, s[48:51], s59 offen
back_22:
    v_pk_mul_f32 v[52:53], v[112:113], v[52:53] op_sel:[1,0]
    v_pk_mul_f32 v[54:55], v[112:113], v[54:55] op_sel:[1,0]
    s_branch SKIP5
PAD5:
    s_branch HOPBACK
SKIP5:
    v_exp_f32 v8, v52
    v_exp_f32 v9, v53
    v_exp_f32 v10, v54
    v_exp_f32_e64 v11, v55
    v_pk_fma_f32 v[8:9], v[8:9], s[76:77], s[76:77] op_sel_hi:[1,0,0]
    v_pk_fma_f32 v[10:11], v[10:11], s[76:77], s[76:77] op_sel_hi:[1,0,0]
    v_pk_fma_f32 v[8:9], v[8:9], v[8:9], s[64:65] op_sel_hi:[1,1,0]
    v_pk_fma_f32 v[10:11], v[10:11], v[10:11], s[64:65] op_sel_hi:[1,1,0]
    v_rcp_f32 v8, v8
    v_rcp_f32 v9, v9
    v_rcp_f32 v10, v10
    v_rcp_f32 v11, v11
    v_pk_fma_f32 v[8:9], v[52:53], v[8:9], v[52:53] neg_lo:[1,0,0] neg_hi:[1,0,0]
    v_pk_fma_f32 v[10:11], v[54:55], v[10:11], v[54:55] neg_lo:[1,0,0] neg_hi:[1,0,0]
    v_cvt_pk_bf16_f32 v50, v8, v9
    v_cvt_pk_bf16_f32 v51, v10, v11
    buffer_store_dwordx4 v[48:51], v138, s[48:51], s66 offen offset:0 sc1
    v_pk_mul_f32 v[56:57], v[112:113], v[56:57] op_sel:[1,0]
    v_pk_mul_f32 v[58:59], v[112:113], v[58:59] op_sel:[1,0]
    v_exp_f32 v4, v56
    v_exp_f32 v5, v57
    v_exp_f32 v6, v58
    v_exp_f32 v7, v59
    v_pk_fma_f32 v[4:5], v[4:5], s[76:77], s[76:77] op_sel_hi:[1,0,0]
    v_pk_fma_f32 v[6:7], v[6:7], s[76:77], s[76:77] op_sel_hi:[1,0,0]
    v_pk_fma_f32 v[4:5], v[4:5], v[4:5], s[64:65] op_sel_hi:[1,1,0]
    v_pk_fma_f32 v[6:7], v[6:7], v[6:7], s[64:65] op_sel_hi:[1,1,0]
    v_rcp_f32 v4, v4
    v_rcp_f32 v5, v5
    v_rcp_f32 v6, v6
    v_rcp_f32 v7, v7
    v_pk_fma_f32 v[4:5], v[56:57], v[4:5], v[56:57] neg_lo:[1,0,0] neg_hi:[1,0,0]
    v_pk_fma_f32 v[6:7], v[58:59], v[6:7], v[58:59] neg_lo:[1,0,0] neg_hi:[1,0,0]
    v_cvt_pk_bf16_f32 v52, v4, v5
    v_cvt_pk_bf16_f32 v53, v6, v7
    v_pk_mul_f32 v[60:61], v[112:113], v[60:61] op_sel:[1,0]
    v_pk_mul_f32 v[62:63], v[112:113], v[62:63] op_sel:[1,0]
    v_exp_f32 v8, v60
    v_exp_f32 v9, v61
    v_exp_f32 v10, v62
    v_exp_f32 v11, v63
    v_pk_fma_f32 v[8:9], v[8:9], s[76:77], s[76:77] op_sel_hi:[1,0,0]
    v_pk_fma_f32 v[10:11], v[10:11], s[76:77], s[76:77] op_sel_hi:[1,0,0]
    v_pk_fma_f32 v[8:9], v[8:9], v[8:9], s[64:65] op_sel_hi:[1,1,0]
    v_pk_fma_f32 v[10:11], v[10:11], v[10:11], s[64:65] op_sel_hi:[1,1,0]
    v_rcp_f32 v8, v8
    v_rcp_f32 v9, v9
    v_rcp_f32 v10, v10
    v_rcp_f32 v11, v11
    v_pk_fma_f32 v[8:9], v[60:61], v[8:9], v[60:61] neg_lo:[1,0,0] neg_hi:[1,0,0]
    v_pk_fma_f32 v[10:11], v[62:63], v[10:11], v[62:63] neg_lo:[1,0,0] neg_hi:[1,0,0]
    v_cvt_pk_bf16_f32 v54, v8, v9
    v_cvt_pk_bf16_f32 v55, v10, v11
    buffer_store_dwordx4 v[52:55], v138, s[48:51], s66 offen offset:256 sc1
    s_nop 1
    v_permlane16_swap_b32 v48, v52
    v_permlane16_swap_b32 v49, v53
    v_permlane16_swap_b32 v50, v54
    v_permlane16_swap_b32 v51, v55
    v_pk_mul_f32 v[64:65], v[112:113], v[64:65] op_sel:[1,0]
    v_pk_mul_f32 v[66:67], v[112:113], v[66:67] op_sel:[1,0]
    v_exp_f32 v4, v64
    v_exp_f32 v5, v65
    v_exp_f32 v6, v66
    v_exp_f32_e64 v7, v67
    v_pk_fma_f32 v[4:5], v[4:5], s[76:77], s[76:77] op_sel_hi:[1,0,0]
    v_pk_fma_f32 v[6:7], v[6:7], s[76:77], s[76:77] op_sel_hi:[1,0,0]
    v_pk_fma_f32 v[4:5], v[4:5], v[4:5], s[64:65] op_sel_hi:[1,1,0]
    v_pk_fma_f32 v[6:7], v[6:7], v[6:7], s[64:65] op_sel_hi:[1,1,0]
    v_rcp_f32 v4, v4
    v_rcp_f32 v5, v5
    v_rcp_f32_e64 v6, v6
    buffer_load_dword v15, v14, s[48:51], s58 offen sc1
    v_rcp_f32_e64 v7, v7
    v_pk_fma_f32 v[4:5], v[64:65], v[4:5], v[64:65] neg_lo:[1,0,0] neg_hi:[1,0,0]
    v_pk_fma_f32 v[6:7], v[66:67], v[6:7], v[66:67] neg_lo:[1,0,0] neg_hi:[1,0,0]
    v_cvt_pk_bf16_f32 v56, v4, v5
    v_cvt_pk_bf16_f32 v57, v6, v7
    v_pk_mul_f32 v[68:69], v[112:113], v[68:69] op_sel:[1,0]
    v_pk_mul_f32 v[70:71], v[112:113], v[70:71] op_sel:[1,0]
    v_exp_f32 v8, v68
    v_exp_f32 v9, v69
    v_exp_f32 v10, v70
    v_exp_f32 v11, v71
    v_pk_fma_f32 v[8:9], v[8:9], s[76:77], s[76:77] op_sel_hi:[1,0,0]
    v_pk_fma_f32 v[10:11], v[10:11], s[76:77], s[76:77] op_sel_hi:[1,0,0]
    v_pk_fma_f32 v[8:9], v[8:9], v[8:9], s[64:65] op_sel_hi:[1,1,0]
    v_pk_fma_f32 v[10:11], v[10:11], v[10:11], s[64:65] op_sel_hi:[1,1,0]
    v_rcp_f32 v8, v8
    v_rcp_f32 v9, v9
    v_rcp_f32 v10, v10
    v_rcp_f32 v11, v11
    v_pk_fma_f32 v[8:9], v[68:69], v[8:9], v[68:69] neg_lo:[1,0,0] neg_hi:[1,0,0]
    v_pk_fma_f32 v[10:11], v[70:71], v[10:11], v[70:71] neg_lo:[1,0,0] neg_hi:[1,0,0]
    v_cvt_pk_bf16_f32 v58, v8, v9
    v_cvt_pk_bf16_f32 v59, v10, v11
    buffer_store_dwordx4 v[56:59], v138, s[48:51], s66 offen offset:2048 sc1
    v_pk_mul_f32 v[72:73], v[112:113], v[72:73] op_sel:[1,0]
    v_pk_mul_f32 v[74:75], v[112:113], v[74:75] op_sel:[1,0]
    v_exp_f32 v4, v72
    v_exp_f32 v5, v73
    v_exp_f32 v6, v74
    v_exp_f32 v7, v75
    v_pk_fma_f32 v[4:5], v[4:5], s[76:77], s[76:77] op_sel_hi:[1,0,0]
    v_pk_fma_f32 v[6:7], v[6:7], s[76:77], s[76:77] op_sel_hi:[1,0,0]
    v_pk_fma_f32 v[4:5], v[4:5], v[4:5], s[64:65] op_sel_hi:[1,1,0]
    v_pk_fma_f32 v[6:7], v[6:7], v[6:7], s[64:65] op_sel_hi:[1,1,0]
    v_rcp_f32 v4, v4
    v_rcp_f32 v5, v5
    v_rcp_f32 v6, v6
    v_rcp_f32 v7, v7
    v_pk_fma_f32 v[4:5], v[72:73], v[4:5], v[72:73] neg_lo:[1,0,0] neg_hi:[1,0,0]
    v_pk_fma_f32 v[6:7], v[74:75], v[6:7], v[74:75] neg_lo:[1,0,0] neg_hi:[1,0,0]
    v_cvt_pk_bf16_f32 v60, v4, v5
    v_cvt_pk_bf16_f32 v61, v6, v7
    v_pk_mul_f32 v[76:77], v[112:113], v[76:77] op_sel:[1,0]
    v_pk_mul_f32 v[78:79], v[112:113], v[78:79] op_sel:[1,0]
    v_exp_f32 v8, v76
    v_exp_f32 v9, v77
    v_exp_f32 v10, v78
    v_exp_f32 v11, v79
    v_pk_fma_f32 v[8:9], v[8:9], s[76:77], s[76:77] op_sel_hi:[1,0,0]
    v_pk_fma_f32 v[10:11], v[10:11], s[76:77], s[76:77] op_sel_hi:[1,0,0]
    v_pk_fma_f32 v[8:9], v[8:9], v[8:9], s[64:65] op_sel_hi:[1,1,0]
    v_pk_fma_f32 v[10:11], v[10:11], v[10:11], s[64:65] op_sel_hi:[1,1,0]
    v_rcp_f32 v8, v8
    v_rcp_f32 v9, v9
    v_rcp_f32 v10, v10
    v_rcp_f32 v11, v11
    v_pk_fma_f32 v[8:9], v[76:77], v[8:9], v[76:77] neg_lo:[1,0,0] neg_hi:[1,0,0]
    v_pk_fma_f32 v[10:11], v[78:79], v[10:11], v[78:79] neg_lo:[1,0,0] neg_hi:[1,0,0]
    v_cvt_pk_bf16_f32 v62, v8, v9
    v_cvt_pk_bf16_f32 v63, v10, v11
    buffer_store_dwordx4 v[60:63], v138, s[48:51], s66 offen offset:2304 sc1
    v_mfma_f32_16x16x32_bf16 v[32:35], a[224:227], v[16:19], 0
    ds_read_b64_tr_b16 a[24:25], v134 offset:10240
    v_permlane16_swap_b32 v24, v28
    v_mfma_f32_16x16x32_bf16 v[40:43], a[228:231], v[16:19], 0
    ds_read_b64_tr_b16 a[26:27], v134 offset:11264
    v_permlane16_swap_b32 v25, v29
    v_mfma_f32_16x16x32_bf16 v[116:119], a[232:235], v[16:19], 0
    ds_read_b64_tr_b16 a[28:29], v248 offset:10240
    v_permlane16_swap_b32 v26, v30
    v_mfma_f32_16x16x32_bf16 v[124:127], a[236:239], v[16:19], 0
    ds_read_b64_tr_b16 a[30:31], v248 offset:11264
    v_permlane16_swap_b32 v27, v31
    v_mfma_f32_16x16x32_bf16 v[36:39], a[224:227], v[20:23], 0
    ds_read_b64_tr_b16 a[32:33], v135 offset:10240
    ds_read_b64_tr_b16 a[34:35], v135 offset:11264
    v_mfma_f32_16x16x32_bf16 v[44:47], a[228:231], v[20:23], 0
    ds_read_b64_tr_b16 a[36:37], v249 offset:10240
    ds_read_b64_tr_b16 a[38:39], v249 offset:11264
    v_mfma_f32_16x16x32_bf16 v[120:123], a[232:235], v[20:23], 0
    ds_read_b64_tr_b16 a[40:41], v132 offset:0
    ds_read_b64_tr_b16 a[42:43], v132 offset:1024
    v_mfma_f32_16x16x32_bf16 v[128:131], a[236:239], v[20:23], 0
    ds_read_b64_tr_b16 a[44:45], v238 offset:0
    ds_read_b64_tr_b16 a[46:47], v238 offset:1024
    v_mfma_f32_16x16x32_bf16 v[32:35], a[240:243], v[24:27], v[32:35]
    ds_read_b64_tr_b16 a[48:49], v133 offset:0
    ds_read_b64_tr_b16 a[50:51], v133 offset:1024
    v_mfma_f32_16x16x32_bf16 v[40:43], a[244:247], v[24:27], v[40:43]
    ds_read_b64_tr_b16 a[52:53], v239 offset:0
    ds_read_b64_tr_b16 a[54:55], v239 offset:1024
    v_mfma_f32_16x16x32_bf16 v[116:119], a[248:251], v[24:27], v[116:119]
    ds_read_b64_tr_b16 a[56:57], v132 offset:4096
    ds_read_b64_tr_b16 a[58:59], v132 offset:5120
    v_mfma_f32_16x16x32_bf16 v[124:127], a[252:255], v[24:27], v[124:127]
    ds_read_b64_tr_b16 a[60:61], v238 offset:4096
    ds_read_b64_tr_b16 a[62:63], v238 offset:5120
    v_mfma_f32_16x16x32_bf16 v[36:39], a[240:243], v[28:31], v[36:39]
    ds_read_b64_tr_b16 a[64:65], v133 offset:4096
    ds_read_b64_tr_b16 a[66:67], v133 offset:5120
    v_mfma_f32_16x16x32_bf16 v[44:47], a[244:247], v[28:31], v[44:47]
    ds_read_b64_tr_b16 a[68:69], v239 offset:4096
    ds_read_b64_tr_b16 a[70:71], v239 offset:5120
    v_mfma_f32_16x16x32_bf16 v[120:123], a[248:251], v[28:31], v[120:123]
    ds_read_b64_tr_b16 a[72:73], v136 offset:8192
    ds_read_b64_tr_b16 a[74:75], v136 offset:9216
    v_mfma_f32_16x16x32_bf16 v[128:131], a[252:255], v[28:31], v[128:131]
    ds_read_b64_tr_b16 a[76:77], v252 offset:8192
    ds_read_b64_tr_b16 a[78:79], v252 offset:9216
    v_mfma_f32_16x16x32_bf16 v[64:67], a[224:227], v[48:51], 0
    ds_read_b64_tr_b16 a[80:81], v137 offset:8192
    v_permlane16_swap_b32 v56, v60
    v_mfma_f32_16x16x32_bf16 v[72:75], a[228:231], v[48:51], 0
    ds_read_b64_tr_b16 a[82:83], v137 offset:9216
    v_permlane16_swap_b32 v57, v61
    v_mfma_f32_16x16x32_bf16 v[144:147], a[232:235], v[48:51], 0
    ds_read_b64_tr_b16 a[84:85], v253 offset:8192
    v_permlane16_swap_b32 v58, v62
    v_mfma_f32_16x16x32_bf16 v[152:155], a[236:239], v[48:51], 0
    ds_read_b64_tr_b16 a[86:87], v253 offset:9216
    v_permlane16_swap_b32 v59, v63
    v_mfma_f32_16x16x32_bf16 v[68:71], a[224:227], v[52:55], 0
    s_waitcnt vmcnt(2)
    v_cmp_ne_u32_e64 vcc, s57, v15
    s_cbranch_vccz polld_34
    s_mov_b32 s69, 1000000
poll_33:
    buffer_load_dword v15, v14, s[48:51], s58 offen sc1
    s_waitcnt vmcnt(0)
    v_cmp_ne_u32 vcc, s57, v15
    s_cbranch_vccz polld_34
    s_sub_u32 s69, s69, 1
    s_cbranch_scc0 poll_33
polld_34:
    v_mfma_f32_16x16x32_bf16 v[76:79], a[228:231], v[52:55], 0
    buffer_load_dwordx4 a[120:123], v251, s[48:51], s17 offen offset:0 sc1
    v_mfma_f32_16x16x32_bf16 v[148:151], a[232:235], v[52:55], 0
    buffer_load_dwordx4 a[124:127], v251, s[48:51], s17 offen offset:1024 sc1
    v_mfma_f32_16x16x32_bf16 v[156:159], a[236:239], v[52:55], 0
    s_waitcnt vmcnt(2)
    s_cmp_lg_u32 s27, 0
    s_cbranch_scc0 rem_23
    buffer_store_dword v12, v13, s[48:51], s63 offen
back_24:
    v_mfma_f32_16x16x32_bf16 v[64:67], a[240:243], v[56:59], v[64:67]
    buffer_load_dwordx4 a[128:131], v251, s[48:51], s17 offen offset:2048 sc1
    v_mfma_f32_16x16x32_bf16 v[72:75], a[244:247], v[56:59], v[72:75]
    buffer_load_dwordx4 a[132:135], v251, s[48:51], s17 offen offset:3072 sc1
    v_mfma_f32_16x16x32_bf16 v[144:147], a[248:251], v[56:59], v[144:147]
    buffer_load_dwordx4 a[136:139], v251, s[48:51], s18 offen offset:0 sc1
    v_mfma_f32_16x16x32_bf16 v[152:155], a[252:255], v[56:59], v[152:155]
    buffer_load_dwordx4 a[140:143], v251, s[48:51], s18 offen offset:1024 sc1
    v_mfma_f32_16x16x32_bf16 v[68:71], a[240:243], v[60:63], v[68:71]
    buffer_load_dwordx4 a[144:147], v251, s[48:51], s18 offen offset:2048 sc1
    v_mfma_f32_16x16x32_bf16 v[76:79], a[244:247], v[60:63], v[76:79]
    buffer_load_dwordx4 a[148:151], v251, s[48:51], s18 offen offset:3072 sc1
    v_mfma_f32_16x16x32_bf16 v[148:151], a[248:251], v[60:63], v[148:151]
    buffer_load_dwordx4 a[152:155], v251, s[48:51], s19 offen offset:0 sc1
    v_mfma_f32_16x16x32_bf16 v[156:159], a[252:255], v[60:63], v[156:159]
    buffer_load_dwordx4 a[156:159], v251, s[48:51], s19 offen offset:1024 sc1
    s_mov_b32 s64, 0x3f317218
    s_mov_b32 s65, 57344
    ds_read_b64_tr_b16 a[88:89], v134 offset:2048
    ds_read_b64_tr_b16 a[90:91], v134 offset:3072
    ds_read_b64_tr_b16 a[92:93], v248 offset:2048
    ds_read_b64_tr_b16 a[94:95], v248 offset:3072
    ds_read_b64_tr_b16 a[96:97], v135 offset:2048
    ds_read_b64_tr_b16 a[98:99], v135 offset:3072
    ds_read_b64_tr_b16 a[100:101], v249 offset:2048
    ds_read_b64_tr_b16 a[102:103], v249 offset:3072
    ds_read_b64_tr_b16 a[104:105], v134 offset:6144
    ds_read_b64_tr_b16 a[106:107], v134 offset:7168
    ds_read_b64_tr_b16 a[108:109], v248 offset:6144
    ds_read_b64_tr_b16 a[110:111], v248 offset:7168
    ds_read_b64_tr_b16 a[112:113], v135 offset:6144
    ds_read_b64_tr_b16 a[114:115], v135 offset:7168
    ds_read_b64_tr_b16 a[116:117], v249 offset:6144
    ds_read_b64_tr_b16 a[118:119], v249 offset:7168
    buffer_load_dword v15, v14, s[48:51], s62 offen sc1
    buffer_load_dwordx4 a[160:163], v251, s[48:51], s19 offen offset:2048 sc1
    buffer_load_dwordx4 a[164:167], v251, s[48:51], s19 offen offset:3072 sc1
    s_waitcnt vmcnt(13)
    v_mfma_f32_16x16x32_bf16 v[32:35], v[160:163], a[120:123], v[32:35]
    v_mfma_f32_16x16x32_bf16 v[40:43], v[164:167], a[120:123], v[40:43]
    v_mfma_f32_16x16x32_bf16 v[116:119], v[168:171], a[120:123], v[116:119]
    buffer_load_dwordx4 a[168:171], v251, s[48:51], s20 offen offset:0 sc1
    v_mfma_f32_16x16x32_bf16 v[124:127], v[172:175], a[120:123], v[124:127]
    s_waitcnt vmcnt(13)
    v_mfma_f32_16x16x32_bf16 v[36:39], v[160:163], a[124:127], v[36:39]
    v_mfma_f32_16x16x32_bf16 v[44:47], v[164:167], a[124:127], v[44:47]
    v_mfma_f32_16x16x32_bf16 v[120:123], v[168:171], a[124:127], v[120:123]
    buffer_load_dwordx4 a[172:175], v251, s[48:51], s20 offen offset:1024 sc1
    v_mfma_f32_16x16x32_bf16 v[128:131], v[172:175], a[124:127], v[128:131]
    s_waitcnt vmcnt(12)
    v_mfma_f32_16x16x32_bf16 v[32:35], v[176:179], a[128:131], v[32:35]
    v_mfma_f32_16x16x32_bf16 v[40:43], v[180:183], a[128:131], v[40:43]
    buffer_load_dwordx4 a[176:179], v251, s[48:51], s20 offen offset:2048 sc1
    v_mfma_f32_16x16x32_bf16 v[116:119], v[184:187], a[128:131], v[116:119]
    v_mfma_f32_16x16x32_bf16 v[124:127], v[188:191], a[128:131], v[124:127]
    s_waitcnt vmcnt(12)
    v_mfma_f32_16x16x32_bf16 v[36:39], v[176:179], a[132:135], v[36:39]
    v_mfma_f32_16x16x32_bf16 v[44:47], v[180:183], a[132:135], v[44:47]
    buffer_load_dwordx4 a[180:183], v251, s[48:51], s20 offen offset:3072 sc1
    v_mfma_f32_16x16x32_bf16 v[120:123], v[184:187], a[132:135], v[120:123]
    v_mfma_f32_16x16x32_bf16 v[128:131], v[188:191], a[132:135], v[128:131]
    s_waitcnt vmcnt(12)
    v_mfma_f32_16x16x32_bf16 v[32:35], v[192:195], a[136:139], v[32:35]
    v_mfma_f32_16x16x32_bf16 v[40:43], v[196:199], a[136:139], v[40:43]
    buffer_load_dwordx4 a[184:187], v251, s[48:51], s21 offen offset:0 sc1
    v_mfma_f32_16x16x32_bf16 v[116:119], v[206:209], a[136:139], v[116:119]
    v_mfma_f32_16x16x32_bf16 v[124:127], v[210:213], a[136:139], v[124:127]
    s_waitcnt vmcnt(12)
    v_mfma_f32_16x16x32_bf16 v[36:39], v[192:195], a[140:143], v[36:39]
    v_mfma_f32_16x16x32_bf16 v[44:47], v[196:199], a[140:143], v[44:47]
    buffer_load_dwordx4 a[188:191], v251, s[48:51], s21 offen offset:1024 sc1
    v_mfma_f32_16x16x32_bf16 v[120:123], v[206:209], a[140:143], v[120:123]
    v_mfma_f32_16x16x32_bf16 v[128:131], v[210:213], a[140:143], v[128:131]
    s_waitcnt vmcnt(12)
    v_mfma_f32_16x16x32_bf16 v[32:35], v[214:217], a[144:147], v[32:35]
    v_mfma_f32_16x16x32_bf16 v[40:43], v[218:221], a[144:147], v[40:43]
    buffer_load_dwordx4 a[192:195], v251, s[48:51], s21 offen offset:2048 sc1
    v_mfma_f32_16x16x32_bf16 v[116:119], v[222:225], a[144:147], v[116:119]
    v_mfma_f32_16x16x32_bf16 v[124:127], v[226:229], a[144:147], v[124:127]
    s_waitcnt vmcnt(12)
    v_mfma_f32_16x16x32_bf16 v[36:39], v[214:217], a[148:151], v[36:39]
    v_mfma_f32_16x16x32_bf16 v[44:47], v[218:221], a[148:151], v[44:47]
    buffer_load_dwordx4 a[196:199], v251, s[48:51], s21 offen offset:3072 sc1
    v_mfma_f32_16x16x32_bf16 v[120:123], v[222:225], a[148:151], v[120:123]
    v_mfma_f32_16x16x32_bf16 v[128:131], v[226:229], a[148:151], v[128:131]
    s_waitcnt vmcnt(12)
    s_waitcnt vmcnt(10)
    v_cmp_ne_u32 vcc, s57, v15
    s_cbranch_vccz polld_36
    s_mov_b32 s69, 1000000
poll_35:
    buffer_load_dword v15, v14, s[48:51], s62 offen sc1
    s_waitcnt vmcnt(0)
    v_cmp_ne_u32 vcc, s57, v15
    s_cbranch_vccz polld_36
    s_sub_u32 s69, s69, 1
    s_cbranch_scc0 poll_35
polld_36:
    v_mfma_f32_16x16x32_bf16 v[32:35], v[230:233], a[152:155], v[32:35]
    v_mfma_f32_16x16x32_bf16 v[40:43], v[234:237], a[152:155], v[40:43]
    buffer_load_dwordx4 a[200:203], v251, s[48:51], s22 offen offset:0 sc1
    v_mfma_f32_16x16x32_bf16 v[116:119], a[0:3], a[152:155], v[116:119]
    v_mfma_f32_16x16x32_bf16 v[124:127], a[4:7], a[152:155], v[124:127]
    v_mfma_f32_16x16x32_bf16 v[36:39], v[230:233], a[156:159], v[36:39]
    v_mfma_f32_16x16x32_bf16 v[44:47], v[234:237], a[156:159], v[44:47]
    buffer_load_dwordx4 a[204:207], v251, s[48:51], s22 offen offset:1024 sc1
    v_mfma_f32_16x16x32_bf16 v[120:123], a[0:3], a[156:159], v[120:123]
    v_mfma_f32_16x16x32_bf16 v[128:131], a[4:7], a[156:159], v[128:131]
    buffer_load_dwordx4 a[208:211], v251, s[48:51], s22 offen offset:2048 sc1
    s_waitcnt vmcnt(12)
    v_mfma_f32_16x16x32_bf16 v[32:35], a[8:11], a[160:163], v[32:35]
    v_mfma_f32_16x16x32_bf16 v[40:43], a[12:15], a[160:163], v[40:43]
    v_mfma_f32_16x16x32_bf16 v[116:119], a[16:19], a[160:163], v[116:119]
    v_mfma_f32_16x16x32_bf16 v[124:127], a[20:23], a[160:163], v[124:127]
    s_waitcnt vmcnt(11)
    v_mfma_f32_16x16x32_bf16 v[36:39], a[8:11], a[164:167], v[36:39]
    buffer_load_dwordx4 a[212:215], v251, s[48:51], s22 offen offset:3072 sc1
    v_mfma_f32_16x16x32_bf16 v[44:47], a[12:15], a[164:167], v[44:47]
    v_mfma_f32_16x16x32_bf16 v[120:123], a[16:19], a[164:167], v[120:123]
    v_mfma_f32_16x16x32_bf16 v[128:131], a[20:23], a[164:167], v[128:131]
    s_waitcnt vmcnt(11)
    buffer_load_dwordx4 a[120:123], v3, s[48:51], s17 offen offset:0 sc1
    s_waitcnt lgkmcnt(15)
    v_mfma_f32_16x16x32_bf16 v[32:35], a[24:27], a[168:171], v[32:35]
    v_mfma_f32_16x16x32_bf16 v[40:43], a[28:31], a[168:171], v[40:43]
    v_mfma_f32_16x16x32_bf16 v[116:119], a[32:35], a[168:171], v[116:119]
    v_mfma_f32_16x16x32_bf16 v[124:127], a[36:39], a[168:171], v[124:127]
    s_waitcnt vmcnt(11)
    v_mfma_f32_16x16x32_bf16 v[36:39], a[24:27], a[172:175], v[36:39]
    buffer_load_dwordx4 a[124:127], v3, s[48:51], s17 offen offset:1024 sc1
    v_mfma_f32_16x16x32_bf16 v[44:47], a[28:31], a[172:175], v[44:47]
    v_mfma_f32_16x16x32_bf16 v[120:123], a[32:35], a[172:175], v[120:123]
    v_mfma_f32_16x16x32_bf16 v[128:131], a[36:39], a[172:175], v[128:131]
    s_waitcnt vmcnt(11)
    v_mfma_f32_16x16x32_bf16 v[32:35], a[40:43], a[176:179], v[32:35]
    buffer_load_dwordx4 a[128:131], v3, s[48:51], s17 offen offset:2048 sc1
    v_mfma_f32_16x16x32_bf16 v[40:43], a[44:47], a[176:179], v[40:43]
    v_mfma_f32_16x16x32_bf16 v[116:119], a[48:51], a[176:179], v[116:119]
    v_mfma_f32_16x16x32_bf16 v[124:127], a[52:55], a[176:179], v[124:127]
    s_waitcnt vmcnt(11)
    v_mfma_f32_16x16x32_bf16 v[36:39], a[40:43], a[180:183], v[36:39]
    buffer_load_dwordx4 a[132:135], v3, s[48:51], s17 offen offset:3072 sc1
    v_mfma_f32_16x16x32_bf16 v[44:47], a[44:47], a[180:183], v[44:47]
    v_mfma_f32_16x16x32_bf16 v[120:123], a[48:51], a[180:183], v[120:123]
    v_mfma_f32_16x16x32_bf16 v[128:131], a[52:55], a[180:183], v[128:131]
    s_waitcnt vmcnt(11)
    buffer_load_dwordx4 a[136:139], v3, s[48:51], s18 offen offset:0 sc1
    v_mfma_f32_16x16x32_bf16 v[32:35], a[56:59], a[184:187], v[32:35]
    v_mfma_f32_16x16x32_bf16 v[40:43], a[60:63], a[184:187], v[40:43]
    v_mfma_f32_16x16x32_bf16 v[116:119], a[64:67], a[184:187], v[116:119]
    v_mfma_f32_16x16x32_bf16 v[124:127], a[68:71], a[184:187], v[124:127]
    s_waitcnt vmcnt(11)
    v_mfma_f32_16x16x32_bf16 v[36:39], a[56:59], a[188:191], v[36:39]
    buffer_load_dwordx4 a[140:143], v3, s[48:51], s18 offen offset:1024 sc1
    v_mfma_f32_16x16x32_bf16 v[44:47], a[60:63], a[188:191], v[44:47]
    v_mfma_f32_16x16x32_bf16 v[120:123], a[64:67], a[188:191], v[120:123]
    v_mfma_f32_16x16x32_bf16 v[128:131], a[68:71], a[188:191], v[128:131]
    s_waitcnt vmcnt(11)
    v_mfma_f32_16x16x32_bf16 v[32:35], a[72:75], a[192:195], v[32:35]
    buffer_load_dwordx4 a[144:147], v3, s[48:51], s18 offen offset:2048 sc1
    v_mfma_f32_16x16x32_bf16 v[40:43], a[76:79], a[192:195], v[40:43]
    v_mfma_f32_16x16x32_bf16 v[116:119], a[80:83], a[192:195], v[116:119]
    v_mfma_f32_16x16x32_bf16 v[124:127], a[84:87], a[192:195], v[124:127]
    s_waitcnt vmcnt(11)
    v_mfma_f32_16x16x32_bf16 v[36:39], a[72:75], a[196:199], v[36:39]
    buffer_load_dwordx4 a[148:151], v3, s[48:51], s18 offen offset:3072 sc1
    v_mfma_f32_16x16x32_bf16 v[44:47], a[76:79], a[196:199], v[44:47]
    v_mfma_f32_16x16x32_bf16 v[120:123], a[80:83], a[196:199], v[120:123]
    v_mfma_f32_16x16x32_bf16 v[128:131], a[84:87], a[196:199], v[128:131]
    s_waitcnt vmcnt(11)
    buffer_load_dwordx4 a[152:155], v3, s[48:51], s19 offen offset:0 sc1
    s_waitcnt lgkmcnt(14)
    v_mfma_f32_16x16x32_bf16 v[32:35], a[88:91], a[200:203], v[32:35]
    s_waitcnt lgkmcnt(12)
    v_mfma_f32_16x16x32_bf16 v[40:43], a[92:95], a[200:203], v[40:43]
    s_waitcnt lgkmcnt(10)
    v_mfma_f32_16x16x32_bf16 v[116:119], a[96:99], a[200:203], v[116:119]
    s_waitcnt lgkmcnt(8)
    v_mfma_f32_16x16x32_bf16 v[124:127], a[100:103], a[200:203], v[124:127]
    s_waitcnt vmcnt(11)
    v_mfma_f32_16x16x32_bf16 v[36:39], a[88:91], a[204:207], v[36:39]
    buffer_load_dwordx4 a[156:159], v3, s[48:51], s19 offen offset:1024 sc1
    v_mfma_f32_16x16x32_bf16 v[44:47], a[92:95], a[204:207], v[44:47]
    v_mfma_f32_16x16x32_bf16 v[120:123], a[96:99], a[204:207], v[120:123]
    v_mfma_f32_16x16x32_bf16 v[128:131], a[100:103], a[204:207], v[128:131]
    s_waitcnt vmcnt(11)
    s_waitcnt lgkmcnt(6)
    v_mfma_f32_16x16x32_bf16 v[32:35], a[104:107], a[208:211], v[32:35]
    buffer_load_dwordx4 a[160:163], v3, s[48:51], s19 offen offset:2048 sc1
    s_waitcnt lgkmcnt(4)
    v_mfma_f32_16x16x32_bf16 v[40:43], a[108:111], a[208:211], v[40:43]
    s_waitcnt lgkmcnt(2)
    v_mfma_f32_16x16x32_bf16 v[116:119], a[112:115], a[208:211], v[116:119]
    s_waitcnt lgkmcnt(0)
    v_mfma_f32_16x16x32_bf16 v[124:127], a[116:119], a[208:211], v[124:127]
    s_waitcnt vmcnt(11)
    v_mfma_f32_16x16x32_bf16 v[36:39], a[104:107], a[212:215], v[36:39]
    buffer_load_dwordx4 a[164:167], v3, s[48:51], s19 offen offset:3072 sc1
    v_mfma_f32_16x16x32_bf16 v[44:47], a[108:111], a[212:215], v[44:47]
    v_mfma_f32_16x16x32_bf16 v[120:123], a[112:115], a[212:215], v[120:123]
    v_mfma_f32_16x16x32_bf16 v[128:131], a[116:119], a[212:215], v[128:131]
    s_waitcnt vmcnt(11)
    buffer_load_dwordx4 a[168:171], v3, s[48:51], s20 offen offset:0 sc1
    v_mfma_f32_16x16x32_bf16 v[64:67], v[160:163], a[120:123], v[64:67]
    v_mfma_f32_16x16x32_bf16 v[72:75], v[164:167], a[120:123], v[72:75]
    v_mfma_f32_16x16x32_bf16 v[144:147], v[168:171], a[120:123], v[144:147]
    v_mfma_f32_16x16x32_bf16 v[152:155], v[172:175], a[120:123], v[152:155]
    s_waitcnt vmcnt(11)
    v_mfma_f32_16x16x32_bf16 v[68:71], v[160:163], a[124:127], v[68:71]
    buffer_load_dwordx4 a[172:175], v3, s[48:51], s20 offen offset:1024 sc1
    v_mfma_f32_16x16x32_bf16 v[76:79], v[164:167], a[124:127], v[76:79]
    ds_write_b128 v96, v[40:43] offset:0
    v_mfma_f32_16x16x32_bf16 v[148:151], v[168:171], a[124:127], v[148:151]
    ds_write_b128 v96, v[44:47] offset:1024
    v_mfma_f32_16x16x32_bf16 v[156:159], v[172:175], a[124:127], v[156:159]
    buffer_load_dwordx4 a[176:179], v3, s[48:51], s20 offen offset:2048 sc1
    s_waitcnt vmcnt(12)
    v_mfma_f32_16x16x32_bf16 v[64:67], v[176:179], a[128:131], v[64:67]
    ds_write_b128 v96, v[116:119] offset:2048
    v_mfma_f32_16x16x32_bf16 v[72:75], v[180:183], a[128:131], v[72:75]
    ds_write_b128 v96, v[120:123] offset:3072
    v_mfma_f32_16x16x32_bf16 v[144:147], v[184:187], a[128:131], v[144:147]
    buffer_load_dwordx4 a[180:183], v3, s[48:51], s20 offen offset:3072 sc1
    v_mfma_f32_16x16x32_bf16 v[152:155], v[188:191], a[128:131], v[152:155]
    ds_write_b128 v96, v[124:127] offset:4096
    s_waitcnt vmcnt(12)
    v_mfma_f32_16x16x32_bf16 v[68:71], v[176:179], a[132:135], v[68:71]
    buffer_load_dwordx4 a[184:187], v3, s[48:51], s21 offen offset:0 sc1
    v_mfma_f32_16x16x32_bf16 v[76:79], v[180:183], a[132:135], v[76:79]
    ds_write_b128 v96, v[128:131] offset:5120
    v_mfma_f32_16x16x32_bf16 v[148:151], v[184:187], a[132:135], v[148:151]
    ds_read_b64_tr_b16 v[104:105], v142 offset:0
    ds_read_b64_tr_b16 v[106:107], v142 offset:32
    v_mfma_f32_16x16x32_bf16 v[156:159], v[188:191], a[132:135], v[156:159]
    s_waitcnt vmcnt(12)
    v_mfma_f32_16x16x32_bf16 v[64:67], v[192:195], a[136:139], v[64:67]
    buffer_load_dwordx4 a[188:191], v3, s[48:51], s21 offen offset:1024 sc1
    v_mfma_f32_16x16x32_bf16 v[72:75], v[196:199], a[136:139], v[72:75]
    v_mfma_f32_16x16x32_bf16 v[144:147], v[206:209], a[136:139], v[144:147]
    v_mfma_f32_16x16x32_bf16 v[152:155], v[210:213], a[136:139], v[152:155]
    s_waitcnt vmcnt(12)
    v_mfma_f32_16x16x32_bf16 v[68:71], v[192:195], a[140:143], v[68:71]
    buffer_load_dwordx4 a[192:195], v3, s[48:51], s21 offen offset:2048 sc1
    v_mfma_f32_16x16x32_bf16 v[76:79], v[196:199], a[140:143], v[76:79]
    s_waitcnt lgkmcnt(2)
    s_barrier
    v_mfma_f32_16x16x32_bf16 v[148:151], v[206:209], a[140:143], v[148:151]
    ds_read_b128 v[80:83], v139 offset:0
    ds_read_b128 v[84:87], v139 offset:1024
    v_mfma_f32_16x16x32_bf16 v[156:159], v[210:213], a[140:143], v[156:159]
    ds_read_b128 v[88:91], v140 offset:0
    ds_read_b128 v[92:95], v140 offset:1024
    s_waitcnt vmcnt(12)
    v_mfma_f32_16x16x32_bf16 v[64:67], v[214:217], a[144:147], v[64:67]
    buffer_load_dwordx4 a[196:199], v3, s[48:51], s21 offen offset:3072 sc1
    v_mfma_f32_16x16x32_bf16 v[72:75], v[218:221], a[144:147], v[72:75]
    v_mfma_f32_16x16x32_bf16 v[144:147], v[222:225], a[144:147], v[144:147]
    v_mfma_f32_16x16x32_bf16 v[152:155], v[226:229], a[144:147], v[152:155]
    s_waitcnt vmcnt(12)
    s_waitcnt lgkmcnt(5)
    v_lshlrev_b32 v4, 16, v104
    v_and_b32 v5, 0xffff0000, v104
    v_mfma_f32_16x16x32_bf16 v[68:71], v[214:217], a[148:151], v[68:71]
    buffer_load_dwordx4 a[200:203], v3, s[48:51], s22 offen offset:0 sc1
    v_mfma_f32_16x16x32_bf16 v[76:79], v[218:221], a[148:151], v[76:79]
    v_lshlrev_b32_e64 v6, 16, v105
    v_and_b32 v7, 0xffff0000, v105
    v_mfma_f32_16x16x32_bf16 v[148:151], v[222:225], a[148:151], v[148:151]
    s_waitcnt lgkmcnt(4)
    v_lshlrev_b32 v8, 16, v106
    v_and_b32 v9, 0xffff0000, v106
    v_mfma_f32_16x16x32_bf16 v[156:159], v[226:229], a[148:151], v[156:159]
    s_waitcnt vmcnt(12)
    v_lshlrev_b32 v10, 16, v107
    v_and_b32 v11, 0xffff0000, v107
    v_mfma_f32_16x16x32_bf16 v[64:67], v[230:233], a[152:155], v[64:67]
    buffer_load_dwordx4 a[204:207], v3, s[48:51], s22 offen offset:1024 sc1
    v_mfma_f32_16x16x32_bf16 v[72:75], v[234:237], a[152:155], v[72:75]
    s_waitcnt lgkmcnt(3)
    v_add_f32 v32, v32, v80
    v_add_f32_e64 v33, v33, v81
    v_mfma_f32_16x16x32_bf16 v[144:147], a[0:3], a[152:155], v[144:147]
    v_add_f32 v34, v34, v82
    v_add_f32 v35, v35, v83
    v_mfma_f32_16x16x32_bf16 v[152:155], a[4:7], a[152:155], v[152:155]
    s_waitcnt vmcnt(12)
    s_waitcnt lgkmcnt(2)
    v_add_f32 v36, v36, v84
    v_add_f32 v37, v37, v85
    v_mfma_f32_16x16x32_bf16 v[68:71], v[230:233], a[156:159], v[68:71]
    buffer_load_dwordx4 a[208:211], v3, s[48:51], s22 offen offset:2048 sc1
    v_mfma_f32_16x16x32_bf16 v[76:79], v[234:237], a[156:159], v[76:79]
    v_add_f32 v38, v38, v86
    v_add_f32 v39, v39, v87
    v_mfma_f32_16x16x32_bf16 v[148:151], a[0:3], a[156:159], v[148:151]
    ds_read_b128 v[80:83], v141 offset:0
    ds_read_b128 v[84:87], v141 offset:1024
    v_mfma_f32_16x16x32_bf16 v[156:159], a[4:7], a[156:159], v[156:159]
    s_waitcnt vmcnt(12)
    s_waitcnt lgkmcnt(3)
    v_add_f32 v32, v32, v88
    v_add_f32 v33, v33, v89
    v_mfma_f32_16x16x32_bf16 v[64:67], a[8:11], a[160:163], v[64:67]
    buffer_load_dwordx4 a[212:215], v3, s[48:51], s22 offen offset:3072 sc1
    v_mfma_f32_16x16x32_bf16 v[72:75], a[12:15], a[160:163], v[72:75]
    v_add_f32 v34, v34, v90
    v_add_f32 v35, v35, v91
    v_mfma_f32_16x16x32_bf16 v[144:147], a[16:19], a[160:163], v[144:147]
    s_waitcnt lgkmcnt(2)
    v_add_f32 v36, v36, v92
    v_add_f32_e64 v37, v37, v93
    v_mfma_f32_16x16x32_bf16 v[152:155], a[20:23], a[160:163], v[152:155]
    s_waitcnt vmcnt(12)
    v_add_f32 v38, v38, v94
    v_add_f32_e64 v39, v39, v95
    v_mfma_f32_16x16x32_bf16 v[68:71], a[8:11], a[164:167], v[68:71]
    s_waitcnt lgkmcnt(1)
    v_add_f32 v32, v32, v80
    v_add_f32_e64 v33, v33, v81
    v_mfma_f32_16x16x32_bf16 v[76:79], a[12:15], a[164:167], v[76:79]
    v_add_f32 v34, v34, v82
    v_add_f32 v35, v35, v83
    v_mfma_f32_16x16x32_bf16 v[148:151], a[16:19], a[164:167], v[148:151]
    s_waitcnt lgkmcnt(0)
    v_add_f32 v36, v36, v84
    v_add_f32_e64 v37, v37, v85
    v_mfma_f32_16x16x32_bf16 v[156:159], a[20:23], a[164:167], v[156:159]
    s_waitcnt vmcnt(11)
    v_add_f32 v38, v38, v86
    v_add_f32 v39, v39, v87
    v_mfma_f32_16x16x32_bf16 v[64:67], a[24:27], a[168:171], v[64:67]
    v_fma_f32 v32, v32, s64, v4
    v_fma_f32 v33, v33, s64, v5
    v_mfma_f32_16x16x32_bf16 v[72:75], a[28:31], a[168:171], v[72:75]
    v_fma_f32 v34, v34, s64, v6
    v_fma_f32 v35, v35, s64, v7
    v_mfma_f32_16x16x32_bf16 v[144:147], a[32:35], a[168:171], v[144:147]
    v_fma_f32 v36, v36, s64, v8
    v_fma_f32 v37, v37, s64, v9
    v_mfma_f32_16x16x32_bf16 v[152:155], a[36:39], a[168:171], v[152:155]
    s_waitcnt vmcnt(10)
    v_fma_f32 v38, v38, s64, v10
    v_fma_f32 v39, v39, s64, v11
    v_mfma_f32_16x16x32_bf16 v[68:71], a[24:27], a[172:175], v[68:71]
    v_cvt_pk_bf16_f32 v104, v32, v33
    v_cvt_pk_bf16_f32 v105, v34, v35
    v_mfma_f32_16x16x32_bf16 v[76:79], a[28:31], a[172:175], v[76:79]
    v_cvt_pk_bf16_f32 v106, v36, v37
    v_cvt_pk_bf16_f32 v107, v38, v39
    v_mfma_f32_16x16x32_bf16 v[148:151], a[32:35], a[172:175], v[148:151]
    v_permlane16_swap_b32 v104, v106
    v_permlane16_swap_b32 v105, v107
    v_mfma_f32_16x16x32_bf16 v[156:159], a[36:39], a[172:175], v[156:159]
    buffer_store_dwordx4 v[104:107], v143, s[40:43], 0 offen
    s_waitcnt vmcnt(10)
    v_mfma_f32_16x16x32_bf16 v[64:67], a[40:43], a[176:179], v[64:67]
    v_mfma_f32_16x16x32_bf16 v[72:75], a[44:47], a[176:179], v[72:75]
    v_mfma_f32_16x16x32_bf16 v[144:147], a[48:51], a[176:179], v[144:147]
    v_mfma_f32_16x16x32_bf16 v[152:155], a[52:55], a[176:179], v[152:155]
    s_waitcnt vmcnt(9)
    v_mfma_f32_16x16x32_bf16 v[68:71], a[40:43], a[180:183], v[68:71]
    v_mfma_f32_16x16x32_bf16 v[76:79], a[44:47], a[180:183], v[76:79]
    v_mfma_f32_16x16x32_bf16 v[148:151], a[48:51], a[180:183], v[148:151]
    v_mfma_f32_16x16x32_bf16 v[156:159], a[52:55], a[180:183], v[156:159]
    s_waitcnt vmcnt(8)
    v_mfma_f32_16x16x32_bf16 v[64:67], a[56:59], a[184:187], v[64:67]
    v_mfma_f32_16x16x32_bf16 v[72:75], a[60:63], a[184:187], v[72:75]
    v_mfma_f32_16x16x32_bf16 v[144:147], a[64:67], a[184:187], v[144:147]
    v_mfma_f32_16x16x32_bf16 v[152:155], a[68:71], a[184:187], v[152:155]
    s_waitcnt vmcnt(7)
    v_mfma_f32_16x16x32_bf16 v[68:71], a[56:59], a[188:191], v[68:71]
    v_mfma_f32_16x16x32_bf16 v[76:79], a[60:63], a[188:191], v[76:79]
    v_mfma_f32_16x16x32_bf16 v[148:151], a[64:67], a[188:191], v[148:151]
    v_mfma_f32_16x16x32_bf16 v[156:159], a[68:71], a[188:191], v[156:159]
    s_waitcnt vmcnt(6)
    v_mfma_f32_16x16x32_bf16 v[64:67], a[72:75], a[192:195], v[64:67]
    v_mfma_f32_16x16x32_bf16 v[72:75], a[76:79], a[192:195], v[72:75]
    v_mfma_f32_16x16x32_bf16 v[144:147], a[80:83], a[192:195], v[144:147]
    s_branch SKIP6
PAD6:
    s_branch HOPBACK
SKIP6:
    v_mfma_f32_16x16x32_bf16 v[152:155], a[84:87], a[192:195], v[152:155]
    s_waitcnt vmcnt(5)
    v_mfma_f32_16x16x32_bf16 v[68:71], a[72:75], a[196:199], v[68:71]
    v_mfma_f32_16x16x32_bf16 v[76:79], a[76:79], a[196:199], v[76:79]
    v_mfma_f32_16x16x32_bf16 v[148:151], a[80:83], a[196:199], v[148:151]
    v_mfma_f32_16x16x32_bf16 v[156:159], a[84:87], a[196:199], v[156:159]
    s_waitcnt vmcnt(4)
    v_mfma_f32_16x16x32_bf16 v[64:67], a[88:91], a[200:203], v[64:67]
    v_xor_b32 v142, 64, v142
    v_mfma_f32_16x16x32_bf16 v[72:75], a[92:95], a[200:203], v[72:75]
    ds_read_b64_tr_b16 v[108:109], v142 offset:0
    ds_read_b64_tr_b16 v[110:111], v142 offset:32
    v_mfma_f32_16x16x32_bf16 v[144:147], a[96:99], a[200:203], v[144:147]
    v_mfma_f32_16x16x32_bf16 v[152:155], a[100:103], a[200:203], v[152:155]
    s_waitcnt vmcnt(3)
    v_mfma_f32_16x16x32_bf16 v[68:71], a[88:91], a[204:207], v[68:71]
    v_mfma_f32_16x16x32_bf16 v[76:79], a[92:95], a[204:207], v[76:79]
    v_mfma_f32_16x16x32_bf16 v[148:151], a[96:99], a[204:207], v[148:151]
    v_mfma_f32_16x16x32_bf16 v[156:159], a[100:103], a[204:207], v[156:159]
    s_waitcnt vmcnt(2)
    v_mfma_f32_16x16x32_bf16 v[72:75], a[108:111], a[208:211], v[72:75]
    v_mfma_f32_16x16x32_bf16 v[144:147], a[112:115], a[208:211], v[144:147]
    v_mfma_f32_16x16x32_bf16 v[152:155], a[116:119], a[208:211], v[152:155]
    v_mfma_f32_16x16x32_bf16 v[64:67], a[104:107], a[208:211], v[64:67]
    s_waitcnt vmcnt(1)
    v_mfma_f32_16x16x32_bf16 v[76:79], a[108:111], a[212:215], v[76:79]
    s_nop 2
    ds_write_b128 v96, v[72:75] offset:6144
    v_mfma_f32_16x16x32_bf16 v[148:151], a[112:115], a[212:215], v[148:151]
    ds_write_b128 v96, v[144:147] offset:8192
    v_mfma_f32_16x16x32_bf16 v[156:159], a[116:119], a[212:215], v[156:159]
    ds_write_b128 v96, v[152:155] offset:10240
    v_mfma_f32_16x16x32_bf16 v[68:71], a[104:107], a[212:215], v[68:71]
    ds_write_b128 v96, v[76:79] offset:7168
    s_nop 2
    ds_write_b128 v96, v[148:151] offset:9216
    s_nop 0
    ds_write_b128 v96, v[156:159] offset:11264
    s_waitcnt lgkmcnt(0)
    s_barrier
    ds_read_b128 v[160:163], v139 offset:6144
    ds_read_b128 v[164:167], v139 offset:7168
    ds_read_b128 v[168:171], v140 offset:6144
    ds_read_b128 v[172:175], v140 offset:7168
    ds_read_b128 v[176:179], v141 offset:6144
    ds_read_b128 v[180:183], v141 offset:7168
    v_lshlrev_b32_e64 v4, 16, v108
    v_and_b32 v5, 0xffff0000, v108
    v_lshlrev_b32_e64 v6, 16, v109
    v_and_b32 v7, 0xffff0000, v109
    v_lshlrev_b32_e64 v8, 16, v110
    v_and_b32 v9, 0xffff0000, v110
    v_lshlrev_b32_e64 v10, 16, v111
    v_and_b32 v11, 0xffff0000, v111
    s_waitcnt lgkmcnt(5)
    v_pk_add_f32 v[64:65], v[64:65], v[160:161]
    v_pk_add_f32 v[66:67], v[66:67], v[162:163]
    s_waitcnt lgkmcnt(4)
    v_pk_add_f32 v[68:69], v[68:69], v[164:165]
    v_pk_add_f32 v[70:71], v[70:71], v[166:167]
    s_waitcnt lgkmcnt(3)
    v_pk_add_f32 v[64:65], v[64:65], v[168:169]
    v_pk_add_f32 v[66:67], v[66:67], v[170:171]
    s_waitcnt lgkmcnt(2)
    v_pk_add_f32 v[68:69], v[68:69], v[172:173]
    v_pk_add_f32 v[70:71], v[70:71], v[174:175]
    s_waitcnt lgkmcnt(1)
    v_pk_add_f32 v[64:65], v[64:65], v[176:177]
    v_pk_add_f32 v[66:67], v[66:67], v[178:179]
    s_waitcnt lgkmcnt(0)
    v_pk_add_f32 v[68:69], v[68:69], v[180:181]
    v_pk_add_f32 v[70:71], v[70:71], v[182:183]
    v_pk_fma_f32 v[64:65], v[64:65], s[64:65], v[4:5] op_sel_hi:[1,0,1]
    v_pk_fma_f32 v[66:67], v[66:67], s[64:65], v[6:7] op_sel_hi:[1,0,1]
    v_pk_fma_f32 v[68:69], v[68:69], s[64:65], v[8:9] op_sel_hi:[1,0,1]
    v_pk_fma_f32 v[70:71], v[70:71], s[64:65], v[10:11] op_sel_hi:[1,0,1]
    v_cvt_pk_bf16_f32 v108, v64, v65
    v_cvt_pk_bf16_f32 v109, v66, v67
    v_cvt_pk_bf16_f32 v110, v68, v69
    v_cvt_pk_bf16_f32 v111, v70, v71
    s_nop 0
    v_permlane16_swap_b32 v108, v110
    v_permlane16_swap_b32 v109, v111
    buffer_store_dwordx4 v[108:111], v143, s[40:43], s65 offen
FIN:
END:
    s_endpgm
IDLE:
    s_waitcnt vmcnt(0)
    s_branch FIN
HELP:
    s_mov_b32 s30, 1605632
    s_add_u32 s58, s54, 3
    s_and_b32 s58, s58, 3
    s_mul_i32 s58, s58, 401408
    s_mul_i32 s59, s56, 14336
    s_add_u32 s58, s58, s59
    s_lshl_b32 s59, s54, 7
    s_add_u32 s58, s58, s59
    v_min_u32 v6, 55, v1
    v_mul_u32_u24 v7, 37, v6
    v_lshrrev_b32 v7, 8, v7
    v_mul_u32_u24 v8, 7, v7
    v_sub_u32 v6, v6, v8
    v_lshrrev_b32 v8, 2, v7
    v_and_b32 v7, 3, v7
    v_lshl_add_u32 v7, v8, 4, v7
    v_mul_u32_u24 v7, 3584, v7
    v_lshl_add_u32 v9, v6, 9, v7
    buffer_load_dword v50, v9, s[28:31], s58 offen
    s_add_u32 s58, s58, 114688
    buffer_load_dword v51, v9, s[28:31], s58 offen
    s_add_u32 s58, s58, 114688
    buffer_load_dword v52, v9, s[28:31], s58 offen
    s_add_u32 s58, s58, 114688
    buffer_load_dword v53, v9, s[28:31], s58 offen
    s_add_u32 s58, s58, 114688
    s_cmp_eq_u32 s27, 0
    s_cbranch_scc1 HELP2
    s_sub_u32 s58, s53, 28
    s_and_b32 s60, s58, 2
    s_lshl_b32 s60, s60, 20
    s_lshl_b32 s59, s52, 18
    s_add_u32 s59, s59, s60
    s_and_b32 s60, s58, 1
    s_mul_i32 s60, s60, 28
    s_add_u32 s60, s60, s54
    s_lshl_b32 s60, s60, 12
    s_add_u32 s59, s59, s60
    s_lshl_b32 s58, s58, 2
    s_add_u32 s58, s58, s54
    v_and_b32_e64 v4, 31, v1
    v_lshlrev_b32 v4, 7, v4
    s_lshl_b32 s60, s52, 4
    s_add_u32 s60, s60, s58
    s_lshl_b32 s60, s60, 7
    s_add_u32 s60, s60, 17301504
    v_and_b32 v5, 1, v1
    v_lshlrev_b32 v5, 17, v5
    buffer_load_dword v15, v5, s[48:51], s60 offen
    buffer_load_dword v40, v4, s[48:51], s59 offen
    s_add_u32 s59, s59, 16384
    buffer_load_dword v41, v4, s[48:51], s59 offen
    s_add_u32 s59, s59, 16384
    buffer_load_dword v42, v4, s[48:51], s59 offen
    s_add_u32 s59, s59, 16384
    buffer_load_dword v43, v4, s[48:51], s59 offen
    s_add_u32 s59, s59, 16384
    buffer_load_dword v44, v4, s[48:51], s59 offen
    s_add_u32 s59, s59, 16384
    buffer_load_dword v45, v4, s[48:51], s59 offen
    s_add_u32 s59, s59, 16384
    buffer_load_dword v46, v4, s[48:51], s59 offen
    s_add_u32 s59, s59, 16384
HELP2:
    s_waitcnt vmcnt(0)
    s_branch FIN
CODE_END:
rem_5:
    buffer_store_dwordx4 v[84:87], v14, s[48:51], 0 offen offset:0 sc1
    buffer_store_dwordx4 v[88:91], v14, s[48:51], 0 offen offset:64 sc1
    s_waitcnt vmcnt(0)
    buffer_store_dword v39, v158, s[48:51], s76 offen sc1
    s_branch back_6
rem_7:
    buffer_store_dwordx4 v[60:63], v14, s[48:51], s63 offen offset:0 sc1
    buffer_store_dwordx4 v[64:67], v14, s[48:51], s63 offen offset:64 sc1
    s_branch back_8
rem_11:
    buffer_store_dword v39, v158, s[48:51], s76 offen sc1
    s_branch back_12
rem_21:
    buffer_store_dword v12, v13, s[48:51], s59 offen sc1
    s_branch back_22
rem_23:
    buffer_store_dword v12, v13, s[48:51], s63 offen sc1
    s_branch back_24
rem_25:
    buffer_store_dwordx4 v[16:19], v138, s[48:51], s16 offen offset:0 sc1
    s_branch back_26
rem_27:
    buffer_store_dwordx4 v[20:23], v138, s[48:51], s16 offen offset:256 sc1
    s_branch back_28
rem_29:
    buffer_store_dwordx4 v[24:27], v138, s[48:51], s16 offen offset:2048 sc1
    s_branch back_30
rem_31:
    buffer_store_dwordx4 v[28:31], v138, s[48:51], s16 offen offset:2304 sc1
    s_branch back_32
.section .rodata,"a"
.p2align 6
.amdhsa_kernel sequential_preLN__ssm_conv_h3__dense_activation_mish__prompt_kernel
  .amdhsa_next_free_vgpr 512
  .amdhsa_next_free_sgpr 102
  .amdhsa_accum_offset 256
  .amdhsa_group_segment_fixed_size 0
  .amdhsa_kernarg_size 104
  .amdhsa_user_sgpr_count 2
  .amdhsa_user_sgpr_kernarg_segment_ptr 1
  .amdhsa_system_sgpr_workgroup_id_x 1
.end_amdhsa_kernel
```
